```python
import torch

def _softmax(x, axis=-1):
    return torch.softmax(x, dim=axis)
def _gelu(x):
    return torch.nn.functional.gelu(x, approximate="tanh")
def _silu(x):
    return torch.nn.functional.silu(x)
def _sigmoid(x):
    return torch.sigmoid(x)
def _layernorm(x, axis=-1, eps=1e-5):
    m = x.mean(dim=axis, keepdim=True)
    v = x.var(dim=axis, keepdim=True, unbiased=False)
    return (x - m) / torch.sqrt(v + eps)
def _scatter_add(tgt, idx, src, axis=0):
    return tgt.clone().index_add_(axis, idx, src)
def _segment_sum(src, seg, n):
    out = torch.zeros((n,) + src.shape[1:], dtype=src.dtype)
    return out.index_add_(0, seg, src)
def _pad(x, pw):
    flat = tuple(v for pair in reversed(pw) for v in pair)
    return torch.nn.functional.pad(x, flat)

kernel_name = 'concat_heads__ssm_conv_s4d__linear_kernel_hedgehog__prompt'

def setup_inputs():

    _w = (lambda a: (lambda t: t.to(torch.bfloat16) if t.is_floating_point() else t)(torch.as_tensor(a)))
    def _A_setup():
        Bsz, L, D, N = 1, 2048, 576, 128
        return {
            "u": _w((lambda *s: torch.randn(*s, dtype=torch.bfloat16) * 0.05)(Bsz, L, D)),
            "log_A_real": _w((lambda *s: torch.randn(*s, dtype=torch.bfloat16) * 3.2)(D, N) * 0.5),
            "A_imag": _w((lambda *s: torch.randn(*s, dtype=torch.bfloat16) * 0.2)(D, N) * 3.14),
            "C_real": _w((lambda *s: torch.randn(*s, dtype=torch.bfloat16) * 3.2)(D, N) / N ** 0.5),
            "C_imag": _w((lambda *s: torch.randn(*s, dtype=torch.bfloat16) * 3.2)(D, N) / N ** 0.5),
            "log_dt": _w((lambda *s: torch.randn(*s, dtype=torch.bfloat16) * 0.2)(D) * 0.5 - 4.0),
            "D_skip": _w((lambda *s: torch.randn(*s, dtype=torch.bfloat16) * 0.4)(D)),
        }
    _A_in = _A_setup()

    def _B_setup():
        B, S, D, H = 1, 2048, 576, 32
        Dh = D // H
        return {
            "x": _w((lambda *s: torch.randn(*s, dtype=torch.bfloat16) * 0.4)(B, S, D)),
            "wqkv": _w((lambda *s: torch.randn(*s, dtype=torch.bfloat16) * 0.4)(D, 3 * D)),
            "w_phi": _w((lambda *s: torch.randn(*s, dtype=torch.bfloat16) * 0.4)(H, Dh, Dh) * (Dh ** -0.5)),
            "wo": _w((lambda *s: torch.randn(*s, dtype=torch.bfloat16) * 0.05)(D, D)),
        }
    _B_in = _B_setup()

    return {
        "A_u": _A_in["u"],
        "A_log_A_real": _A_in["log_A_real"],
        "A_A_imag": _A_in["A_imag"],
        "A_C_real": _A_in["C_real"],
        "A_C_imag": _A_in["C_imag"],
        "A_log_dt": _A_in["log_dt"],
        "A_D_skip": _A_in["D_skip"],
        "B_x": _B_in["x"],
        "B_wqkv": _B_in["wqkv"],
        "B_w_phi": _B_in["w_phi"],
        "B_wo": _B_in["wo"],
    }

def reference(A_u, A_log_A_real, A_A_imag, A_C_real, A_C_imag, A_log_dt, A_D_skip, B_x, B_wqkv, B_w_phi, B_wo):
    def _A_ref(u, log_A_real, A_imag, C_real, C_imag, log_dt, D_skip):
        L = u.shape[1]
        dt = torch.exp(log_dt)
        A = -torch.exp(log_A_real) + 1j * A_imag
        C = (C_real + 1j * C_imag) * dt[:, None]
        pos = (lambda x, dt: x.to(dt))(torch.arange(L), log_dt.dtype)
        P = torch.exp((A * dt[:, None])[:, :, None] * pos[None, None, :])
        K = 2.0 * torch.einsum("dn,dnl->dl", C, P).real
        L2 = 2 * L
        u_t = (lambda x, *d: x.permute(*d))(u, 0, 2, 1)
        Kf = (lambda x, *a, **k: torch.fft.rfft(x.float(), *a, **k))(K, L2)
        Uf = (lambda x, *a, **k: torch.fft.rfft(x.float(), *a, **k))(u_t, L2)
        y = (lambda x, *a, **k: torch.fft.irfft(x, *a, **k).to(torch.bfloat16))(Uf * Kf[None, :, :], L2)[:, :, :L]
        y = (lambda x, *d: x.permute(*d))(y, 0, 2, 1)
        return y + u * D_skip[None, None, :]

    def _B_ref(x, wqkv, w_phi, wo):
        B, S, D = x.shape
        H = 32; Dh = D // H
        qkv = (lambda x, *d: x.permute(*d))((x @ wqkv).reshape(B, S, 3, H, Dh), 2, 0, 3, 1, 4)
        q, k, v = qkv[0], qkv[1], qkv[2]
        pq = torch.einsum("bhsd,hdf->bhsf", q, w_phi)
        pk = torch.einsum("bhsd,hdf->bhsf", k, w_phi)
        phi_q = torch.concatenate([_softmax(pq, axis=-1), _softmax(-pq, axis=-1)], axis=-1)
        phi_k = torch.concatenate([_softmax(pk, axis=-1), _softmax(-pk, axis=-1)], axis=-1)
        kv = torch.einsum("bhsf,bhsd->bhfd", phi_k, v)
        z  = torch.einsum("bhsf->bhf", phi_k)
        num = torch.einsum("bhqf,bhfd->bhqd", phi_q, kv)
        den = torch.einsum("bhqf,bhf->bhq", phi_q, z)[..., None] + 1e-6
        o = num / den
        return (lambda x, *d: x.permute(*d))(o, 0, 2, 1, 3).reshape(B, S, D) @ wo

    a = _A_ref(A_u, A_log_A_real, A_A_imag, A_C_real, A_C_imag, A_log_dt, A_D_skip)
    b = _B_ref(B_x, B_wqkv, B_w_phi, B_wo)
    return torch.concatenate([a, b], axis=-1)
```

```asm
; @launch grid=(512,1,1) block=(256,1,1) lds=81920
.amdgcn_target "amdgcn-amd-amdhsa--gfx950"
.text
.globl concat_heads__ssm_conv_s4d__linear_kernel_hedgehog__prompt_kernel
.p2align 8
.type concat_heads__ssm_conv_s4d__linear_kernel_hedgehog__prompt_kernel,@function
concat_heads__ssm_conv_s4d__linear_kernel_hedgehog__prompt_kernel:
L_codestart:
  s_cmp_ge_u32 s2, 512
  s_cbranch_scc1 L_end
  s_getpc_b64 s[90:91]
L_pc1:
  s_bfe_u32 s92, s2, 0x50003
  v_lshrrev_b32 v5, 4, v0
  s_lshl_b32 s92, s92, 11
  v_lshl_add_u32 v5, v5, 7, s92
  v_min_u32 v5, L_codeend-L_pc1-4, v5
  global_load_dword v254, v5, s[90:91]
  s_load_dwordx16 s[16:31], s[0:1], 0
  s_load_dwordx8 s[32:39], s[0:1], 64
  s_load_dwordx4 s[40:43], s[0:1], 96
  v_lshrrev_b32 v5, 6, v0
  v_and_b32 v1, 63, v0
  v_readfirstlane_b32 s61, v5
  v_and_b32 v2, 15, v0
  v_bfe_u32 v3, v0, 4, 2
  v_lshlrev_b32 v4, 4, v1
  s_and_b32 s62, s2, 7
  s_bfe_u32 s63, s2, 0x50003
  s_cmp_ge_u32 s2, 256
  s_cbranch_scc1 L_A
  s_setprio 2
  s_mul_i32 s64, s61, 20480
  s_cmp_ge_u32 s63, 27
  s_cbranch_scc1 L_Bwo
  s_movk_i32 s13, 3168
  v_mul_u32_u24 v5, 3641, v1
  v_lshrrev_b32 v5, 16, v5
  v_mad_u32_u24 v208, v5, s13, v4
  v_add_u32 v5, 64, v1
  v_mul_u32_u24 v5, 3641, v5
  v_lshrrev_b32 v5, 16, v5
  v_mad_u32_u24 v209, v5, s13, v4
  v_add_u32 v5, 128, v1
  v_mul_u32_u24 v5, 3641, v5
  v_lshrrev_b32 v5, 16, v5
  v_mad_u32_u24 v210, v5, s13, v4
  s_mul_i32 s12, s62, 27
  s_add_u32 s12, s12, s63
  s_lshr_b32 s4, s12, 2
  s_and_b32 s11, s12, 3
  s_lshl_b32 s3, s11, 2
  s_add_u32 s3, s3, s61
  s_mul_i32 s5, s4, 43
  s_lshr_b32 s5, s5, 7
  s_lshr_b32 s7, s5, 2
  s_lshl_b32 s7, s7, 7
  s_and_b32 s11, s5, 3
  s_lshl_b32 s11, s11, 3
  s_add_u32 s7, s7, s11
  s_lshl_b32 s11, s61, 5
  s_and_b32 s14, s11, 32
  s_lshr_b32 s15, s61, 1
  s_lshl_b32 s15, s15, 4
  s_add_u32 s14, s14, s15
  s_cmp_lt_u32 s5, 16
  s_cselect_b32 s11, s11, s14
  s_add_u32 s7, s7, s11
  s_mul_i32 s7, s7, 3456
  s_mul_i32 s11, s5, 12
  s_sub_u32 s11, s12, s11
  s_mul_i32 s11, s11, 288
  s_add_u32 s7, s7, s11
  s_add_u32 m0, s64, 16384
  s_mul_i32 s11, s3, 1296
  s_mov_b32 s54, 1990656
  s_mov_b32 s55, 0x20000
  s_mov_b32 s58, 20736
  s_mov_b32 s59, 0x20000
  s_add_u32 m0, s64, 18944
  s_waitcnt lgkmcnt(0)
  s_mov_b64 s[56:57], s[34:35]
  buffer_load_dwordx4 v4, s[56:59], s11 offen lds
  s_mov_b64 exec, 0x1ffff
  buffer_load_dwordx4 v4, s[56:59], s11 offen offset:1024 lds
  s_mov_b64 exec, -1
  s_add_u32 m0, s64, 16384
  s_mov_b64 s[52:53], s[32:33]
  buffer_load_dwordx4 v208, s[52:55], s7 offen offset:0  lds
  buffer_load_dwordx4 v209, s[52:55], s7 offen offset:1024  lds
  s_mov_b64 exec, 0xffff
  buffer_load_dwordx4 v210, s[52:55], s7 offen offset:2048  lds
  s_mov_b64 exec, -1
  s_load_dword s60, s[42:43], 0
  s_and_b32 s66, s62, 3
  s_mul_i32 s66, s66, 4
  s_and_b32 s71, s63, 3
  s_add_u32 s66, s66, s71
  s_lshr_b32 s67, s62, 2
  s_mul_i32 s67, s67, 8
  s_lshr_b32 s72, s63, 2
  s_add_u32 s67, s67, s72
  s_and_b32 s68, s72, 3
  s_lshl_b32 s88, s68, 8
  s_lshl_b32 s71, s66, 2
  s_add_u32 s71, s71, s61
  s_mul_i32 s71, s71, 36864
  v_bfe_u32 v5, v1, 2, 2
  v_mul_u32_u24 v5, 4608, v5
  v_and_b32 v6, 3, v1
  v_lshl_add_u32 v5, v6, 4, v5
  v_add_u32 v5, s71, v5
  v_lshl_add_u32 v240, v3, 6, v5
  v_xor_b32 v241, 16, v240
  v_xor_b32 v242, 32, v240
  v_xor_b32 v243, 48, v240
  s_mov_b64 s[48:49], s[30:31]
  s_mov_b32 s50, 2359296
  s_mov_b32 s51, 0x20000
  buffer_load_dwordx4 v[8:11], v240, s[48:51], s88 offen offset:0
  buffer_load_dwordx4 v[16:19], v241, s[48:51], s88 offen offset:1152
  buffer_load_dwordx4 v[24:27], v242, s[48:51], s88 offen offset:2304
  buffer_load_dwordx4 v[32:35], v243, s[48:51], s88 offen offset:3456
  s_add_u32 s89, s88, 256
  s_and_b32 s89, s89, 0x300
  s_add_u32 s93, s89, 256
  s_and_b32 s93, s93, 0x300
  s_add_u32 s94, s93, 256
  s_and_b32 s94, s94, 0x300
  s_mov_b64 s[44:45], s[42:43]
  s_mov_b32 s46, 13631488
  s_mov_b32 s47, 0x20000
  s_mul_i32 s6, s5, 3
  s_sub_u32 s6, s4, s6
  v_mov_b32 v160, 0
  v_mov_b32 v161, 0
  v_mov_b32 v162, 0
  v_mov_b32 v163, 0
  v_mov_b32 v164, 0
  v_mov_b32 v165, 0
  v_mov_b32 v166, 0
  v_mov_b32 v167, 0
  v_mov_b32 v212, 0
  v_mov_b32 v213, 0
  v_mov_b32 v214, 0
  v_mov_b32 v215, 0
  v_add_u32 v5, s64, v4
  ds_write_b128 v5, v[212:215] offset:0
  ds_write_b128 v5, v[212:215] offset:1024
  ds_write_b128 v5, v[212:215] offset:2048
  ds_write_b128 v5, v[212:215] offset:3072
  v_lshrrev_b32 v5, 2, v2
  v_mul_u32_u24 v5, 20480, v5
  v_and_b32 v6, 3, v2
  v_mul_u32_u24 v6, 288, v6
  v_lshl_add_u32 v5, v3, 4, v5
  s_mul_i32 s11, s61, 72
  s_add_u32 s11, s11, 16384
  v_add3_u32 v178, v5, v6, s11
  v_cmp_lt_u32 vcc, 17, v1
  v_mul_u32_u24 v180, 96, v1
  s_nop 0
  v_cndmask_b32 v6, 0, 16, vcc
  v_lshrrev_b32 v7, 2, v6
  v_add3_u32 v216, v180, v7, s64
  v_add3_u32 v180, v180, v6, s64
  v_bfe_u32 v5, v1, 2, 2
  v_and_b32 v6, 3, v1
  v_lshlrev_b32 v6, 3, v6
  v_add_u32 v6, s64, v6
  v_mul_u32_u24 v7, 96, v5
  v_add_u32 v182, v7, v6
  v_mul_u32_u24 v7, 768, v3
  v_add_u32 v181, v7, v182
  s_mul_i32 s11, s3, 18
  s_add_u32 s11, s11, s5
  s_mul_i32 s10, s11, 768
  s_add_u32 s10, s10, 1245184
  s_lshl_b32 s9, s11, 11
  s_add_u32 s9, s9, 1572864
  s_lshl_b32 s11, s11, 12
  s_lshl_b32 s13, s6, 11
  s_add_u32 s11, s11, s13
  s_add_u32 s11, s11, 63488
  s_cmp_eq_u32 s6, 0
  s_cselect_b32 s9, s9, s11
  s_cselect_b32 s13, 3, 0
  s_add_u32 s11, s6, s13
  s_sub_u32 s11, s11, 1
  s_lshl_b32 s13, s11, 2
  v_lshrrev_b32 v5, 2, v2
  v_lshl_add_u32 v5, v3, 2, v5
  v_add_u32 v5, s13, v5
  v_and_b32 v5, 15, v5
  s_lshl_b32 s13, s11, 8
  v_lshl_add_u32 v183, v5, 4, s13
  v_mov_b32 v190, 0
  v_mov_b32 v191, 0
  v_mov_b32 v198, 0
  v_mov_b32 v199, 0
  v_mov_b32 v206, 0
  v_mov_b32 v207, 0
  s_lshl_b32 s92, s3, 13
  s_lshl_b32 s13, s4, 7
  s_add_u32 s92, s92, s13
  s_add_u32 s92, s92, 12189696
  v_min_u32 v5, 35, v1
  v_mul_u32_u24 v5, 36, v5
  s_add_u32 s11, s64, 18944
  v_add_u32 v179, s11, v5
  s_waitcnt vmcnt(7)
  ds_read2_b32 v[168:169], v179 offset0:0 offset1:1
  ds_read2_b32 v[170:171], v179 offset0:2 offset1:3
  ds_read2_b32 v[172:173], v179 offset0:4 offset1:5
  ds_read2_b32 v[174:175], v179 offset0:6 offset1:7
  ds_read_b32 v176, v179 offset:32
  s_waitcnt lgkmcnt(0)
  v_mov_b32 v177, v176
  s_cmp_lg_u32 s6, 2
  s_cbranch_scc1 Lnv_1
  v_subrev_u32 v5, 18, v1
  v_cndmask_b32 v5, v1, v5, vcc
  v_and_b32 v6, 1, v5
  v_lshlrev_b32 v6, 4, v6
  v_mov_b32 v7, 0x3f80
  v_lshlrev_b32 v6, v6, v7
  v_lshrrev_b32 v5, 1, v5
  v_cmp_eq_u32 s[14:15], 0, v5
  v_cmp_eq_u32 s[90:91], 1, v5
  s_nop 0
  v_cndmask_b32 v168, 0, v6, s[14:15]
  v_cmp_eq_u32 s[14:15], 2, v5
  v_cndmask_b32 v169, 0, v6, s[90:91]
  v_cmp_eq_u32 s[90:91], 3, v5
  v_cndmask_b32 v170, 0, v6, s[14:15]
  v_cmp_eq_u32 s[14:15], 4, v5
  v_cndmask_b32 v171, 0, v6, s[90:91]
  v_cmp_eq_u32 s[90:91], 5, v5
  v_cndmask_b32 v172, 0, v6, s[14:15]
  v_cmp_eq_u32 s[14:15], 6, v5
  v_cndmask_b32 v173, 0, v6, s[90:91]
  v_cmp_eq_u32 s[90:91], 7, v5
  v_cndmask_b32 v174, 0, v6, s[14:15]
  v_cmp_eq_u32 s[14:15], 8, v5
  v_cndmask_b32 v175, 0, v6, s[90:91]
  s_nop 0
  v_cndmask_b32 v176, 0, v6, s[14:15]
Lnv_1:
  s_mul_i32 s60, s60, 1664525
  s_add_u32 s60, s60, 1013904223
  s_mov_b32 exec_hi, 15
  ds_write2_b64 v180, v[168:169], v[172:173] offset0:0 offset1:1
  ds_write2_b64 v180, v[170:171], v[174:175] offset0:4 offset1:5
  ds_write_b16 v180, v176 offset:64
  ds_write_b16_d16_hi v180, v176 offset:72
  s_mov_b32 exec_hi, -1
  ds_read_b64_tr_b16 v[184:185], v181 offset:0
  ds_read_b64_tr_b16 v[186:187], v181 offset:384
  ds_read_b64_tr_b16 v[188:189], v182 offset:3072
  ds_read_b64_tr_b16 v[192:193], v181 offset:32
  ds_read_b64_tr_b16 v[194:195], v181 offset:416
  ds_read_b64_tr_b16 v[196:197], v182 offset:3104
  ds_read_b64_tr_b16 v[200:201], v181 offset:64
  ds_read_b64_tr_b16 v[202:203], v181 offset:448
  ds_read_b64_tr_b16 v[204:205], v182 offset:3136
  s_waitcnt vmcnt(4)
  s_barrier
  ds_read2_b64 v[152:155], v178 offset0:0 offset1:1
  ds_read2_b64 v[156:159], v178 offset0:144 offset1:145
  s_mov_b64 exec, 0xffff
  ds_read_b64 v[160:161], v178 offset:64
  ds_read_b64 v[164:165], v178 offset:1216
  s_mov_b64 exec, -1
  s_waitcnt lgkmcnt(3)
  v_mfma_f32_16x16x32_bf16 v[208:211], v[152:155], v[184:187], 0
  s_waitcnt lgkmcnt(2)
  v_mfma_f32_16x16x32_bf16 v[212:215], v[156:159], v[184:187], 0
  s_waitcnt lgkmcnt(1)
  v_mfma_f32_16x16x32_bf16 v[208:211], v[160:163], v[188:191], v[208:211]
  s_waitcnt lgkmcnt(0)
  v_mfma_f32_16x16x32_bf16 v[212:215], v[164:167], v[188:191], v[212:215]
  v_mfma_f32_16x16x32_bf16 v[216:219], v[152:155], v[192:195], 0
  v_mfma_f32_16x16x32_bf16 v[220:223], v[156:159], v[192:195], 0
  v_mfma_f32_16x16x32_bf16 v[216:219], v[160:163], v[196:199], v[216:219]
  v_mfma_f32_16x16x32_bf16 v[220:223], v[164:167], v[196:199], v[220:223]
  v_mfma_f32_16x16x32_bf16 v[224:227], v[152:155], v[200:203], 0
  v_mfma_f32_16x16x32_bf16 v[228:231], v[156:159], v[200:203], 0
  v_mfma_f32_16x16x32_bf16 v[224:227], v[160:163], v[204:207], v[224:227]
  v_mfma_f32_16x16x32_bf16 v[228:231], v[164:167], v[204:207], v[228:231]
  v_cvt_pk_bf16_f32 v184, v208, v209
  v_cvt_pk_bf16_f32 v185, v210, v211
  v_cvt_pk_bf16_f32 v186, v212, v213
  v_cvt_pk_bf16_f32 v187, v214, v215
  buffer_store_dwordx4 v[184:187], v4, s[44:47], s9 offen offset:0 sc1
  v_cvt_pk_bf16_f32 v188, v216, v217
  v_cvt_pk_bf16_f32 v189, v218, v219
  v_cvt_pk_bf16_f32 v190, v220, v221
  v_cvt_pk_bf16_f32 v191, v222, v223
  buffer_store_dwordx4 v[188:191], v4, s[44:47], s9 offen offset:1024 sc1
  v_cvt_pk_bf16_f32 v192, v224, v225
  v_cvt_pk_bf16_f32 v193, v226, v227
  v_cvt_pk_bf16_f32 v194, v228, v229
  v_cvt_pk_bf16_f32 v195, v230, v231
  s_mov_b32 exec_lo, 0x11111111
  s_mov_b32 exec_hi, 0x11111111
  buffer_store_dwordx4 v[192:195], v183, s[44:47], s10 offen sc1
  s_mov_b64 exec, -1
  s_branch L_Bx
L_Bwo:
  s_mul_i32 s3, s62, 5
  s_add_u32 s3, s3, s63
  s_sub_u32 s3, s3, 27
  s_min_u32 s3, s3, 35
  s_lshr_b32 s4, s3, 1
  s_and_b32 s5, s3, 1
  s_lshl_b32 s5, s5, 1
  s_and_b32 s14, s61, 1
  s_mul_i32 s8, s4, 36
  s_sub_u32 s10, s4, 16
  s_mul_i32 s10, s10, 288
  s_add_u32 s10, s10, 16
  s_cmp_lt_u32 s4, 16
  s_cselect_b32 s8, s8, s10
  s_cselect_b32 s6, 8, 1
  s_cselect_b32 s7, 1, 36
  s_lshr_b32 s10, s61, 1
  s_mul_i32 s10, s10, 18
  s_add_u32 s8, s8, s10
  s_mul_i32 s10, s14, s6
  s_add_u32 s8, s8, s10
  s_mul_i32 s9, s8, 1152
  s_mul_i32 s10, s5, 288
  s_add_u32 s9, s9, s10
  s_mul_i32 s13, s7, 1152
  s_sub_u32 s13, s13, 288
  v_mul_u32_u24 v5, 3641, v1
  v_lshrrev_b32 v5, 16, v5
  v_mad_u32_u24 v208, v5, s13, v4
  v_add_u32 v5, 64, v1
  v_mul_u32_u24 v5, 3641, v5
  v_lshrrev_b32 v5, 16, v5
  v_mad_u32_u24 v209, v5, s13, v4
  v_add_u32 v5, 128, v1
  v_mul_u32_u24 v5, 3641, v5
  v_lshrrev_b32 v5, 16, v5
  v_mad_u32_u24 v210, v5, s13, v4
  s_add_u32 m0, s64, 16384
  s_add_u32 s12, s9, 288
  s_waitcnt lgkmcnt(0)
  s_mov_b64 s[52:53], s[36:37]
  s_mov_b32 s54, 663552
  s_mov_b32 s55, 0x20000
  s_load_dword s60, s[42:43], 0
  buffer_load_dwordx4 v208, s[52:55], s9 offen offset:0  lds
  buffer_load_dwordx4 v209, s[52:55], s9 offen offset:1024  lds
  s_mov_b64 exec, 0xffff
  buffer_load_dwordx4 v210, s[52:55], s9 offen offset:2048  lds
  s_mov_b64 exec, -1
  s_mov_b32 m0, s64
  s_nop 0
  buffer_load_dwordx4 v208, s[52:55], s12 offen offset:0  lds
  buffer_load_dwordx4 v209, s[52:55], s12 offen offset:1024  lds
  s_mov_b64 exec, 0xffff
  buffer_load_dwordx4 v210, s[52:55], s12 offen offset:2048  lds
  s_mov_b64 exec, -1
  s_and_b32 s66, s62, 3
  s_mul_i32 s66, s66, 4
  s_and_b32 s71, s63, 3
  s_add_u32 s66, s66, s71
  s_lshr_b32 s67, s62, 2
  s_mul_i32 s67, s67, 8
  s_lshr_b32 s72, s63, 2
  s_add_u32 s67, s67, s72
  s_and_b32 s68, s72, 3
  s_lshl_b32 s88, s68, 8
  s_lshl_b32 s71, s66, 2
  s_add_u32 s71, s71, s61
  s_mul_i32 s71, s71, 36864
  v_bfe_u32 v5, v1, 2, 2
  v_mul_u32_u24 v5, 4608, v5
  v_and_b32 v6, 3, v1
  v_lshl_add_u32 v5, v6, 4, v5
  v_add_u32 v5, s71, v5
  v_lshl_add_u32 v240, v3, 6, v5
  v_xor_b32 v241, 16, v240
  v_xor_b32 v242, 32, v240
  v_xor_b32 v243, 48, v240
  s_mov_b64 s[48:49], s[30:31]
  s_mov_b32 s50, 2359296
  s_mov_b32 s51, 0x20000
  buffer_load_dwordx4 v[8:11], v240, s[48:51], s88 offen offset:0
  buffer_load_dwordx4 v[16:19], v241, s[48:51], s88 offen offset:1152
  buffer_load_dwordx4 v[24:27], v242, s[48:51], s88 offen offset:2304
  buffer_load_dwordx4 v[32:35], v243, s[48:51], s88 offen offset:3456
  s_add_u32 s89, s88, 256
  s_and_b32 s89, s89, 0x300
  s_add_u32 s93, s89, 256
  s_and_b32 s93, s93, 0x300
  s_add_u32 s94, s93, 256
  s_and_b32 s94, s94, 0x300
  s_mov_b64 s[44:45], s[42:43]
  s_mov_b32 s46, 13631488
  s_mov_b32 s47, 0x20000
  v_lshrrev_b32 v5, 2, v2
  v_mul_u32_u24 v5, 20480, v5
  v_and_b32 v6, 3, v2
  v_mul_u32_u24 v6, 288, v6
  v_lshl_add_u32 v5, v3, 4, v5
  s_cmp_lt_u32 s61, 2
  s_cselect_b32 s10, 16384, 0
  s_lshl_b32 s13, s14, 7
  s_add_u32 s10, s10, s13
  v_add3_u32 v178, v5, v6, s10
  s_lshr_b32 s10, s61, 1
  s_add_u32 s5, s5, s10
  v_lshrrev_b32 v5, 2, v2
  v_and_b32 v6, 1, v2
  v_lshlrev_b32 v6, 4, v6
  v_mov_b32 v7, 0x3f80
  v_lshlrev_b32 v6, v6, v7
  v_bfe_u32 v7, v2, 1, 1
  v_cmp_eq_u32 vcc, v5, v3
  s_nop 1
  v_cndmask_b32 v196, 0, v6, vcc
  v_cmp_eq_u32 vcc, 0, v7
  s_nop 1
  v_cndmask_b32 v186, 0, v196, vcc
  v_cndmask_b32 v187, v196, 0, vcc
  v_mov_b32 v184, 0
  v_mov_b32 v185, 0
  v_mov_b32 v188, 0
  v_mov_b32 v189, 0
  v_mov_b32 v168, 0
  v_mov_b32 v169, 0
  v_mov_b32 v170, 0
  v_mov_b32 v171, 0
  v_mov_b32 v172, 0
  v_mov_b32 v173, 0
  v_mov_b32 v174, 0
  v_mov_b32 v175, 0
  v_lshrrev_b32 v197, 3, v2
  v_cmp_eq_u32 vcc, v197, v3
  s_nop 1
  v_cndmask_b32 v196, 0, v6, vcc
  v_bfe_u32 v197, v2, 1, 2
  v_cmp_eq_u32 vcc, 0, v197
  s_nop 1
  v_cndmask_b32 v192, 0, v196, vcc
  v_cmp_eq_u32 vcc, 1, v197
  s_nop 1
  v_cndmask_b32 v193, 0, v196, vcc
  v_cmp_eq_u32 vcc, 2, v197
  s_nop 1
  v_cndmask_b32 v194, 0, v196, vcc
  v_cmp_eq_u32 vcc, 3, v197
  s_nop 1
  v_cndmask_b32 v195, 0, v196, vcc
  s_mul_i32 s11, s5, 165888
  s_lshl_b32 s10, s4, 10
  s_add_u32 s11, s11, s10
  s_add_u32 s11, s11, 2228224
  s_mul_i32 s10, s14, 73728
  s_add_u32 s11, s11, s10
  s_lshl_b32 s92, s5, 13
  s_lshl_b32 s10, s4, 8
  s_add_u32 s92, s92, s10
  s_lshl_b32 s10, s14, 7
  s_add_u32 s92, s92, s10
  s_add_u32 s92, s92, 12320768
  s_waitcnt lgkmcnt(0)
  s_mul_i32 s60, s60, 1664525
  s_add_u32 s60, s60, 1013904223
  s_waitcnt vmcnt(4)
  s_barrier
  ds_read_b128 v[152:155], v178 offset:0
  ds_read_b128 v[156:159], v178 offset:1152
  ds_read_b128 v[160:163], v178 offset:64
  ds_read_b128 v[164:167], v178 offset:1216
  s_mov_b32 exec_hi, 0
  ds_read_b128 v[168:171], v178 offset:128
  ds_read_b128 v[172:175], v178 offset:1280
  s_mov_b64 exec, -1
  s_cmp_eq_u32 s14, 0
  s_cselect_b32 s15, 13107200, 0
  s_waitcnt lgkmcnt(5)
  v_mfma_f32_16x16x32_bf16 v[208:211], v[152:155], v[186:189], 0
  s_waitcnt lgkmcnt(4)
  v_mfma_f32_16x16x32_bf16 v[212:215], v[156:159], v[186:189], 0
  s_nop 5
  v_cvt_pk_bf16_f32 v200, v208, v209
  v_cvt_pk_bf16_f32 v201, v210, v211
  v_cvt_pk_bf16_f32 v202, v212, v213
  v_cvt_pk_bf16_f32 v203, v214, v215
  buffer_store_dwordx4 v[200:203], v4, s[44:47], s11 offen sc1
  s_add_u32 s11, s11, 18432
  v_mfma_f32_16x16x32_bf16 v[216:219], v[152:155], v[184:187], 0
  v_mfma_f32_16x16x32_bf16 v[220:223], v[156:159], v[184:187], 0
  s_nop 6
  v_cvt_pk_bf16_f32 v204, v216, v217
  v_cvt_pk_bf16_f32 v205, v218, v219
  v_cvt_pk_bf16_f32 v206, v220, v221
  v_cvt_pk_bf16_f32 v207, v222, v223
  buffer_store_dwordx4 v[204:207], v4, s[44:47], s11 offen sc1
  s_add_u32 s11, s11, 18432
  s_waitcnt lgkmcnt(3)
  v_mfma_f32_16x16x32_bf16 v[208:211], v[160:163], v[186:189], 0
  s_waitcnt lgkmcnt(2)
  v_mfma_f32_16x16x32_bf16 v[212:215], v[164:167], v[186:189], 0
  s_nop 5
  v_cvt_pk_bf16_f32 v200, v208, v209
  v_cvt_pk_bf16_f32 v201, v210, v211
  v_cvt_pk_bf16_f32 v202, v212, v213
  v_cvt_pk_bf16_f32 v203, v214, v215
  buffer_store_dwordx4 v[200:203], v4, s[44:47], s11 offen sc1
  s_add_u32 s11, s11, 18432
  v_mfma_f32_16x16x32_bf16 v[216:219], v[160:163], v[184:187], 0
  v_mfma_f32_16x16x32_bf16 v[220:223], v[164:167], v[184:187], 0
  s_nop 6
  v_cvt_pk_bf16_f32 v204, v216, v217
  v_cvt_pk_bf16_f32 v205, v218, v219
  v_cvt_pk_bf16_f32 v206, v220, v221
  v_cvt_pk_bf16_f32 v207, v222, v223
  buffer_store_dwordx4 v[204:207], v4, s[44:47], s11 offen sc1
  s_add_u32 s11, s11, 18432
  s_waitcnt lgkmcnt(1)
  v_mfma_f32_16x16x32_bf16 v[208:211], v[168:171], v[192:195], 0
  s_waitcnt lgkmcnt(0)
  v_mfma_f32_16x16x32_bf16 v[212:215], v[172:175], v[192:195], 0
  s_nop 5
  v_cvt_pk_bf16_f32 v200, v208, v209
  v_cvt_pk_bf16_f32 v201, v210, v211
  v_cvt_pk_bf16_f32 v202, v212, v213
  v_cvt_pk_bf16_f32 v203, v214, v215
  s_max_u32 s11, s11, s15
  buffer_store_dwordx4 v[200:203], v4, s[44:47], s11 offen sc1
L_Bx:
  s_add_u32 s69, s88, 18432
  buffer_load_dwordx4 v[12:15], v240, s[48:51], s69 offen offset:0
  buffer_load_dwordx4 v[20:23], v241, s[48:51], s69 offen offset:1152
  buffer_load_dwordx4 v[28:31], v242, s[48:51], s69 offen offset:2304
  buffer_load_dwordx4 v[36:39], v243, s[48:51], s69 offen offset:3456
  buffer_load_dwordx4 v[40:43], v240, s[48:51], s89 offen offset:0
  buffer_load_dwordx4 v[48:51], v241, s[48:51], s89 offen offset:1152
  buffer_load_dwordx4 v[56:59], v242, s[48:51], s89 offen offset:2304
  buffer_load_dwordx4 v[64:67], v243, s[48:51], s89 offen offset:3456
  s_mov_b32 s14, 0xaaaaaaaa
  s_mov_b32 s15, s14
  s_mov_b32 s90, 0xcccccccc
  s_mov_b32 s91, s90
  v_mov_b32 v5, s60
  s_waitcnt vmcnt(8)
  s_mov_b64 exec, 1
  buffer_store_dword v5, v4, s[44:47], s92 offen sc1
  s_mov_b64 exec, -1
  s_add_u32 s69, s89, 18432
  buffer_load_dwordx4 v[44:47], v240, s[48:51], s69 offen offset:0
  buffer_load_dwordx4 v[52:55], v241, s[48:51], s69 offen offset:1152
  buffer_load_dwordx4 v[60:63], v242, s[48:51], s69 offen offset:2304
  buffer_load_dwordx4 v[68:71], v243, s[48:51], s69 offen offset:3456
  v_mov_b32 v152, v32
  s_mov_b64 exec, s[14:15]
  v_mov_b64 v[152:153], v[8:9]
  v_mov_b64 v[154:155], v[10:11]
  v_mov_b64 v[156:157], v[24:25]
  v_mov_b64 v[158:159], v[26:27]
  v_mov_b64 v[8:9], v[16:17]
  v_mov_b64 v[10:11], v[18:19]
  v_mov_b64 v[24:25], v[32:33]
  v_mov_b64 v[26:27], v[34:35]
  v_mov_b64 v[16:17], v[152:153]
  v_mov_b64 v[18:19], v[154:155]
  v_mov_b64 v[32:33], v[156:157]
  v_mov_b64 v[34:35], v[158:159]
  s_mov_b64 exec, s[90:91]
  v_mov_b64 v[152:153], v[8:9]
  v_mov_b64 v[154:155], v[10:11]
  v_mov_b64 v[156:157], v[16:17]
  v_mov_b64 v[158:159], v[18:19]
  v_mov_b64 v[8:9], v[24:25]
  v_mov_b64 v[10:11], v[26:27]
  v_mov_b64 v[16:17], v[32:33]
  v_mov_b64 v[18:19], v[34:35]
  v_mov_b64 v[24:25], v[152:153]
  v_mov_b64 v[26:27], v[154:155]
  v_mov_b64 v[32:33], v[156:157]
  v_mov_b64 v[34:35], v[158:159]
  s_mov_b64 exec, -1
  v_mov_b32_dpp v16, v16 quad_perm:[1,0,3,2] row_mask:0xf bank_mask:0xf
  v_mov_b32_dpp v17, v17 quad_perm:[1,0,3,2] row_mask:0xf bank_mask:0xf
  v_mov_b32_dpp v18, v18 quad_perm:[1,0,3,2] row_mask:0xf bank_mask:0xf
  v_mov_b32_dpp v19, v19 quad_perm:[1,0,3,2] row_mask:0xf bank_mask:0xf
  v_mov_b32_dpp v24, v24 quad_perm:[2,3,0,1] row_mask:0xf bank_mask:0xf
  v_mov_b32_dpp v25, v25 quad_perm:[2,3,0,1] row_mask:0xf bank_mask:0xf
  v_mov_b32_dpp v26, v26 quad_perm:[2,3,0,1] row_mask:0xf bank_mask:0xf
  v_mov_b32_dpp v27, v27 quad_perm:[2,3,0,1] row_mask:0xf bank_mask:0xf
  v_mov_b32_dpp v32, v32 quad_perm:[3,2,1,0] row_mask:0xf bank_mask:0xf
  v_mov_b32_dpp v33, v33 quad_perm:[3,2,1,0] row_mask:0xf bank_mask:0xf
  v_mov_b32_dpp v34, v34 quad_perm:[3,2,1,0] row_mask:0xf bank_mask:0xf
  v_mov_b32_dpp v35, v35 quad_perm:[3,2,1,0] row_mask:0xf bank_mask:0xf
  buffer_load_dwordx4 v[72:75], v240, s[48:51], s93 offen offset:0
  buffer_load_dwordx4 v[80:83], v241, s[48:51], s93 offen offset:1152
  buffer_load_dwordx4 v[88:91], v242, s[48:51], s93 offen offset:2304
  buffer_load_dwordx4 v[96:99], v243, s[48:51], s93 offen offset:3456
  s_waitcnt vmcnt(13)
  v_mov_b32 v152, v36
  s_mov_b64 exec, s[14:15]
  v_mov_b64 v[152:153], v[12:13]
  v_mov_b64 v[154:155], v[14:15]
  v_mov_b64 v[156:157], v[28:29]
  v_mov_b64 v[158:159], v[30:31]
  v_mov_b64 v[12:13], v[20:21]
  v_mov_b64 v[14:15], v[22:23]
  v_mov_b64 v[28:29], v[36:37]
  v_mov_b64 v[30:31], v[38:39]
  v_mov_b64 v[20:21], v[152:153]
  v_mov_b64 v[22:23], v[154:155]
  v_mov_b64 v[36:37], v[156:157]
  v_mov_b64 v[38:39], v[158:159]
  s_mov_b64 exec, s[90:91]
  v_mov_b64 v[152:153], v[12:13]
  v_mov_b64 v[154:155], v[14:15]
  v_mov_b64 v[156:157], v[20:21]
  v_mov_b64 v[158:159], v[22:23]
  v_mov_b64 v[12:13], v[28:29]
  v_mov_b64 v[14:15], v[30:31]
  v_mov_b64 v[20:21], v[36:37]
  v_mov_b64 v[22:23], v[38:39]
  v_mov_b64 v[28:29], v[152:153]
  v_mov_b64 v[30:31], v[154:155]
  v_mov_b64 v[36:37], v[156:157]
  v_mov_b64 v[38:39], v[158:159]
  s_mov_b64 exec, -1
  v_mov_b32_dpp v20, v20 quad_perm:[1,0,3,2] row_mask:0xf bank_mask:0xf
  v_mov_b32_dpp v21, v21 quad_perm:[1,0,3,2] row_mask:0xf bank_mask:0xf
  v_mov_b32_dpp v22, v22 quad_perm:[1,0,3,2] row_mask:0xf bank_mask:0xf
  v_mov_b32_dpp v23, v23 quad_perm:[1,0,3,2] row_mask:0xf bank_mask:0xf
  v_mov_b32_dpp v28, v28 quad_perm:[2,3,0,1] row_mask:0xf bank_mask:0xf
  v_mov_b32_dpp v29, v29 quad_perm:[2,3,0,1] row_mask:0xf bank_mask:0xf
  v_mov_b32_dpp v30, v30 quad_perm:[2,3,0,1] row_mask:0xf bank_mask:0xf
  v_mov_b32_dpp v31, v31 quad_perm:[2,3,0,1] row_mask:0xf bank_mask:0xf
  v_mov_b32_dpp v36, v36 quad_perm:[3,2,1,0] row_mask:0xf bank_mask:0xf
  v_mov_b32_dpp v37, v37 quad_perm:[3,2,1,0] row_mask:0xf bank_mask:0xf
  v_mov_b32_dpp v38, v38 quad_perm:[3,2,1,0] row_mask:0xf bank_mask:0xf
  v_mov_b32_dpp v39, v39 quad_perm:[3,2,1,0] row_mask:0xf bank_mask:0xf
  s_add_u32 s69, s93, 18432
  buffer_load_dwordx4 v[76:79], v240, s[48:51], s69 offen offset:0
  buffer_load_dwordx4 v[84:87], v241, s[48:51], s69 offen offset:1152
  buffer_load_dwordx4 v[92:95], v242, s[48:51], s69 offen offset:2304
  buffer_load_dwordx4 v[100:103], v243, s[48:51], s69 offen offset:3456
  s_waitcnt vmcnt(13)
  v_mov_b32 v152, v64
  s_mov_b64 exec, s[14:15]
  v_mov_b64 v[152:153], v[40:41]
  v_mov_b64 v[154:155], v[42:43]
  v_mov_b64 v[156:157], v[56:57]
  v_mov_b64 v[158:159], v[58:59]
  v_mov_b64 v[40:41], v[48:49]
  v_mov_b64 v[42:43], v[50:51]
  v_mov_b64 v[56:57], v[64:65]
  v_mov_b64 v[58:59], v[66:67]
  v_mov_b64 v[48:49], v[152:153]
  v_mov_b64 v[50:51], v[154:155]
  v_mov_b64 v[64:65], v[156:157]
  v_mov_b64 v[66:67], v[158:159]
  s_mov_b64 exec, s[90:91]
  v_mov_b64 v[152:153], v[40:41]
  v_mov_b64 v[154:155], v[42:43]
  v_mov_b64 v[156:157], v[48:49]
  v_mov_b64 v[158:159], v[50:51]
  v_mov_b64 v[40:41], v[56:57]
  v_mov_b64 v[42:43], v[58:59]
  v_mov_b64 v[48:49], v[64:65]
  v_mov_b64 v[50:51], v[66:67]
  v_mov_b64 v[56:57], v[152:153]
  v_mov_b64 v[58:59], v[154:155]
  v_mov_b64 v[64:65], v[156:157]
  v_mov_b64 v[66:67], v[158:159]
  s_mov_b64 exec, -1
  v_mov_b32_dpp v48, v48 quad_perm:[1,0,3,2] row_mask:0xf bank_mask:0xf
  v_mov_b32_dpp v49, v49 quad_perm:[1,0,3,2] row_mask:0xf bank_mask:0xf
  v_mov_b32_dpp v50, v50 quad_perm:[1,0,3,2] row_mask:0xf bank_mask:0xf
  v_mov_b32_dpp v51, v51 quad_perm:[1,0,3,2] row_mask:0xf bank_mask:0xf
  v_mov_b32_dpp v56, v56 quad_perm:[2,3,0,1] row_mask:0xf bank_mask:0xf
  v_mov_b32_dpp v57, v57 quad_perm:[2,3,0,1] row_mask:0xf bank_mask:0xf
  v_mov_b32_dpp v58, v58 quad_perm:[2,3,0,1] row_mask:0xf bank_mask:0xf
  v_mov_b32_dpp v59, v59 quad_perm:[2,3,0,1] row_mask:0xf bank_mask:0xf
  v_mov_b32_dpp v64, v64 quad_perm:[3,2,1,0] row_mask:0xf bank_mask:0xf
  v_mov_b32_dpp v65, v65 quad_perm:[3,2,1,0] row_mask:0xf bank_mask:0xf
  v_mov_b32_dpp v66, v66 quad_perm:[3,2,1,0] row_mask:0xf bank_mask:0xf
  v_mov_b32_dpp v67, v67 quad_perm:[3,2,1,0] row_mask:0xf bank_mask:0xf
  buffer_load_dwordx4 v[104:107], v240, s[48:51], s94 offen offset:0
  buffer_load_dwordx4 v[112:115], v241, s[48:51], s94 offen offset:1152
  buffer_load_dwordx4 v[120:123], v242, s[48:51], s94 offen offset:2304
  buffer_load_dwordx4 v[128:131], v243, s[48:51], s94 offen offset:3456
  s_add_u32 s69, s94, 18432
  buffer_load_dwordx4 v[108:111], v240, s[48:51], s69 offen offset:0
  buffer_load_dwordx4 v[116:119], v241, s[48:51], s69 offen offset:1152
  buffer_load_dwordx4 v[124:127], v242, s[48:51], s69 offen offset:2304
  buffer_load_dwordx4 v[132:135], v243, s[48:51], s69 offen offset:3456
  v_lshrrev_b32 v6, 1, v3
  v_mul_u32_u24 v6, 18304, v6
  v_add_u32 v240, v240, v6
  v_add_u32 v241, v241, v6
  v_add_u32 v242, v242, v6
  v_add_u32 v243, v243, v6
  s_movk_i32 s69, 1024
  buffer_load_dwordx4 v[136:139], v240, s[48:51], s69 offen offset:0
  buffer_load_dwordx4 v[144:147], v241, s[48:51], s69 offen offset:1152
  buffer_load_dwordx4 v[140:143], v242, s[48:51], s69 offen offset:2304
  buffer_load_dwordx4 v[148:151], v243, s[48:51], s69 offen offset:3456
  v_and_b32 v5, 3, v2
  v_min_u32 v5, 2, v5
  v_lshrrev_b32 v6, 2, v2
  v_add_u32 v7, v5, v3
  v_lshl_add_u32 v6, v7, 2, v6
  v_and_b32 v6, 15, v6
  v_lshlrev_b32 v6, 4, v6
  v_lshl_add_u32 v232, v5, 8, v6
  v_add_u32 v252, 40960, v4
  s_lshl_b32 s73, s61, 10
  s_mul_i32 s72, s67, 18
  v_min_u32 v5, 752, v4
  s_lshr_b32 s70, s88, 6
  s_add_u32 s70, s70, s61
  s_add_u32 s70, s70, s72
  s_lshl_b32 s75, s70, 12
  s_add_u32 s75, s75, 65536
  s_mul_i32 s70, s70, 768
  s_add_u32 s70, s70, 1245184
  v_add_u32 v246, s70, v5
  s_lshr_b32 s70, s89, 6
  s_add_u32 s70, s70, s61
  s_add_u32 s70, s70, s72
  s_lshl_b32 s76, s70, 12
  s_add_u32 s76, s76, 65536
  s_mul_i32 s70, s70, 768
  s_add_u32 s70, s70, 1244416
  v_add_u32 v247, s70, v5
  s_lshr_b32 s70, s93, 6
  s_add_u32 s70, s70, s61
  s_add_u32 s70, s70, s72
  s_lshl_b32 s77, s70, 12
  s_add_u32 s77, s77, 65536
  s_mul_i32 s70, s70, 768
  s_add_u32 s70, s70, 1243648
  v_add_u32 v248, s70, v5
  s_lshr_b32 s70, s94, 6
  s_add_u32 s70, s70, s61
  s_add_u32 s70, s70, s72
  s_lshl_b32 s78, s70, 12
  s_add_u32 s78, s78, 65536
  s_mul_i32 s70, s70, 768
  s_add_u32 s70, s70, 1242880
  v_add_u32 v249, s70, v5
  s_and_b32 s70, s61, 1
  s_add_u32 s70, s70, 16
  s_add_u32 s70, s70, s72
  s_lshl_b32 s79, s70, 12
  s_add_u32 s79, s79, 65536
  s_mul_i32 s70, s70, 768
  s_add_u32 s70, s70, 1242112
  v_add_u32 v250, s70, v5
  v_min_u32 v5, 53, v1
  v_lshlrev_b32 v251, 7, v5
  s_lshl_b32 s87, s67, 13
  s_add_u32 s87, s87, 12189696
  s_cmp_eq_u32 s61, 0
  s_cselect_b64 exec, -1, 0
  v_mov_b32 v6, 0
  buffer_load_dword v6, v251, s[44:47], s87 offen sc1
  s_mov_b64 exec, -1
  s_waitcnt vmcnt(21)
  v_mov_b32 v152, v68
  s_mov_b64 exec, s[14:15]
  v_mov_b64 v[152:153], v[44:45]
  v_mov_b64 v[154:155], v[46:47]
  v_mov_b64 v[156:157], v[60:61]
  v_mov_b64 v[158:159], v[62:63]
  v_mov_b64 v[44:45], v[52:53]
  v_mov_b64 v[46:47], v[54:55]
  v_mov_b64 v[60:61], v[68:69]
  v_mov_b64 v[62:63], v[70:71]
  v_mov_b64 v[52:53], v[152:153]
  v_mov_b64 v[54:55], v[154:155]
  v_mov_b64 v[68:69], v[156:157]
  v_mov_b64 v[70:71], v[158:159]
  s_mov_b64 exec, s[90:91]
  v_mov_b64 v[152:153], v[44:45]
  v_mov_b64 v[154:155], v[46:47]
  v_mov_b64 v[156:157], v[52:53]
  v_mov_b64 v[158:159], v[54:55]
  v_mov_b64 v[44:45], v[60:61]
  v_mov_b64 v[46:47], v[62:63]
  v_mov_b64 v[52:53], v[68:69]
  v_mov_b64 v[54:55], v[70:71]
  v_mov_b64 v[60:61], v[152:153]
  v_mov_b64 v[62:63], v[154:155]
  v_mov_b64 v[68:69], v[156:157]
  v_mov_b64 v[70:71], v[158:159]
  s_mov_b64 exec, -1
  v_mov_b32_dpp v52, v52 quad_perm:[1,0,3,2] row_mask:0xf bank_mask:0xf
  v_mov_b32_dpp v53, v53 quad_perm:[1,0,3,2] row_mask:0xf bank_mask:0xf
  v_mov_b32_dpp v54, v54 quad_perm:[1,0,3,2] row_mask:0xf bank_mask:0xf
  v_mov_b32_dpp v55, v55 quad_perm:[1,0,3,2] row_mask:0xf bank_mask:0xf
  v_mov_b32_dpp v60, v60 quad_perm:[2,3,0,1] row_mask:0xf bank_mask:0xf
  v_mov_b32_dpp v61, v61 quad_perm:[2,3,0,1] row_mask:0xf bank_mask:0xf
  v_mov_b32_dpp v62, v62 quad_perm:[2,3,0,1] row_mask:0xf bank_mask:0xf
  v_mov_b32_dpp v63, v63 quad_perm:[2,3,0,1] row_mask:0xf bank_mask:0xf
  v_mov_b32_dpp v68, v68 quad_perm:[3,2,1,0] row_mask:0xf bank_mask:0xf
  v_mov_b32_dpp v69, v69 quad_perm:[3,2,1,0] row_mask:0xf bank_mask:0xf
  v_mov_b32_dpp v70, v70 quad_perm:[3,2,1,0] row_mask:0xf bank_mask:0xf
  v_mov_b32_dpp v71, v71 quad_perm:[3,2,1,0] row_mask:0xf bank_mask:0xf
  s_waitcnt vmcnt(17)
  v_mov_b32 v152, v96
  s_mov_b64 exec, s[14:15]
  v_mov_b64 v[152:153], v[72:73]
  v_mov_b64 v[154:155], v[74:75]
  v_mov_b64 v[156:157], v[88:89]
  v_mov_b64 v[158:159], v[90:91]
  v_mov_b64 v[72:73], v[80:81]
  v_mov_b64 v[74:75], v[82:83]
  v_mov_b64 v[88:89], v[96:97]
  v_mov_b64 v[90:91], v[98:99]
  v_mov_b64 v[80:81], v[152:153]
  v_mov_b64 v[82:83], v[154:155]
  v_mov_b64 v[96:97], v[156:157]
  v_mov_b64 v[98:99], v[158:159]
  s_mov_b64 exec, s[90:91]
  v_mov_b64 v[152:153], v[72:73]
  v_mov_b64 v[154:155], v[74:75]
  v_mov_b64 v[156:157], v[80:81]
  v_mov_b64 v[158:159], v[82:83]
  v_mov_b64 v[72:73], v[88:89]
  v_mov_b64 v[74:75], v[90:91]
  v_mov_b64 v[80:81], v[96:97]
  v_mov_b64 v[82:83], v[98:99]
  v_mov_b64 v[88:89], v[152:153]
  v_mov_b64 v[90:91], v[154:155]
  v_mov_b64 v[96:97], v[156:157]
  v_mov_b64 v[98:99], v[158:159]
  s_mov_b64 exec, -1
  v_mov_b32_dpp v80, v80 quad_perm:[1,0,3,2] row_mask:0xf bank_mask:0xf
  v_mov_b32_dpp v81, v81 quad_perm:[1,0,3,2] row_mask:0xf bank_mask:0xf
  v_mov_b32_dpp v82, v82 quad_perm:[1,0,3,2] row_mask:0xf bank_mask:0xf
  v_mov_b32_dpp v83, v83 quad_perm:[1,0,3,2] row_mask:0xf bank_mask:0xf
  v_mov_b32_dpp v88, v88 quad_perm:[2,3,0,1] row_mask:0xf bank_mask:0xf
  v_mov_b32_dpp v89, v89 quad_perm:[2,3,0,1] row_mask:0xf bank_mask:0xf
  v_mov_b32_dpp v90, v90 quad_perm:[2,3,0,1] row_mask:0xf bank_mask:0xf
  v_mov_b32_dpp v91, v91 quad_perm:[2,3,0,1] row_mask:0xf bank_mask:0xf
  v_mov_b32_dpp v96, v96 quad_perm:[3,2,1,0] row_mask:0xf bank_mask:0xf
  v_mov_b32_dpp v97, v97 quad_perm:[3,2,1,0] row_mask:0xf bank_mask:0xf
  v_mov_b32_dpp v98, v98 quad_perm:[3,2,1,0] row_mask:0xf bank_mask:0xf
  v_mov_b32_dpp v99, v99 quad_perm:[3,2,1,0] row_mask:0xf bank_mask:0xf
  s_waitcnt vmcnt(13)
  v_mov_b32 v152, v100
  s_mov_b64 exec, s[14:15]
  v_mov_b64 v[152:153], v[76:77]
  v_mov_b64 v[154:155], v[78:79]
  v_mov_b64 v[156:157], v[92:93]
  v_mov_b64 v[158:159], v[94:95]
  v_mov_b64 v[76:77], v[84:85]
  v_mov_b64 v[78:79], v[86:87]
  v_mov_b64 v[92:93], v[100:101]
  v_mov_b64 v[94:95], v[102:103]
  v_mov_b64 v[84:85], v[152:153]
  v_mov_b64 v[86:87], v[154:155]
  v_mov_b64 v[100:101], v[156:157]
  v_mov_b64 v[102:103], v[158:159]
  s_mov_b64 exec, s[90:91]
  v_mov_b64 v[152:153], v[76:77]
  v_mov_b64 v[154:155], v[78:79]
  v_mov_b64 v[156:157], v[84:85]
  v_mov_b64 v[158:159], v[86:87]
  v_mov_b64 v[76:77], v[92:93]
  v_mov_b64 v[78:79], v[94:95]
  v_mov_b64 v[84:85], v[100:101]
  v_mov_b64 v[86:87], v[102:103]
  v_mov_b64 v[92:93], v[152:153]
  v_mov_b64 v[94:95], v[154:155]
  v_mov_b64 v[100:101], v[156:157]
  v_mov_b64 v[102:103], v[158:159]
  s_mov_b64 exec, -1
  v_mov_b32_dpp v84, v84 quad_perm:[1,0,3,2] row_mask:0xf bank_mask:0xf
  v_mov_b32_dpp v85, v85 quad_perm:[1,0,3,2] row_mask:0xf bank_mask:0xf
  v_mov_b32_dpp v86, v86 quad_perm:[1,0,3,2] row_mask:0xf bank_mask:0xf
  v_mov_b32_dpp v87, v87 quad_perm:[1,0,3,2] row_mask:0xf bank_mask:0xf
  v_mov_b32_dpp v92, v92 quad_perm:[2,3,0,1] row_mask:0xf bank_mask:0xf
  v_mov_b32_dpp v93, v93 quad_perm:[2,3,0,1] row_mask:0xf bank_mask:0xf
  v_mov_b32_dpp v94, v94 quad_perm:[2,3,0,1] row_mask:0xf bank_mask:0xf
  v_mov_b32_dpp v95, v95 quad_perm:[2,3,0,1] row_mask:0xf bank_mask:0xf
  v_mov_b32_dpp v100, v100 quad_perm:[3,2,1,0] row_mask:0xf bank_mask:0xf
  v_mov_b32_dpp v101, v101 quad_perm:[3,2,1,0] row_mask:0xf bank_mask:0xf
  v_mov_b32_dpp v102, v102 quad_perm:[3,2,1,0] row_mask:0xf bank_mask:0xf
  v_mov_b32_dpp v103, v103 quad_perm:[3,2,1,0] row_mask:0xf bank_mask:0xf
  s_cmp_lg_u32 s61, 0
  s_cbranch_scc1 Lwq_2
  s_waitcnt vmcnt(0)
  v_cmp_ne_u32 vcc, s60, v6
  s_nop 0
  s_cbranch_vccz Lwq_2
  s_waitcnt vmcnt(0) lgkmcnt(0)
  s_movk_i32 s65, 3000
Lpoll_3:
  buffer_load_dword v6, v251, s[44:47], s87 offen sc1
  s_sub_u32 s65, s65, 1
  s_cbranch_scc1 Lpolld_4x
  s_waitcnt vmcnt(0)
  v_cmp_ne_u32 vcc, s60, v6
  s_nop 0
  s_cbranch_vccnz Lpoll_3
  s_branch Lpolld_4
Lpolld_4x:
  s_waitcnt vmcnt(0)
Lpolld_4:
Lwq_2:
  s_barrier
  s_setprio 3
  s_mov_b32 m0, s64
  s_mov_b32 exec_hi, 0xffff
  buffer_load_dwordx4 v246, s[44:47], 0 offen offset:0 sc1 lds
  s_mov_b32 exec_hi, -1
  s_add_u32 m0, s64, 8192
  s_nop 0
  buffer_load_dwordx4 v4, s[44:47], s75 offen offset:0 sc1 lds
  buffer_load_dwordx4 v4, s[44:47], s75 offen offset:1024 sc1 lds
  buffer_load_dwordx4 v4, s[44:47], s75 offen offset:2048 sc1 lds
  buffer_load_dwordx4 v4, s[44:47], s75 offen offset:3072 sc1 lds
  s_mov_b32 m0, s64
  s_mov_b32 exec_hi, 0xffff
  buffer_load_dwordx4 v247, s[44:47], 0 offen offset:768 sc1 lds
  s_mov_b32 exec_hi, -1
  s_add_u32 m0, s64, 12288
  s_nop 0
  buffer_load_dwordx4 v4, s[44:47], s76 offen offset:0 sc1 lds
  buffer_load_dwordx4 v4, s[44:47], s76 offen offset:1024 sc1 lds
  buffer_load_dwordx4 v4, s[44:47], s76 offen offset:2048 sc1 lds
  buffer_load_dwordx4 v4, s[44:47], s76 offen offset:3072 sc1 lds
  s_waitcnt vmcnt(19)
  v_mov_b32 v152, v128
  s_mov_b64 exec, s[14:15]
  v_mov_b64 v[152:153], v[104:105]
  v_mov_b64 v[154:155], v[106:107]
  v_mov_b64 v[156:157], v[120:121]
  v_mov_b64 v[158:159], v[122:123]
  v_mov_b64 v[104:105], v[112:113]
  v_mov_b64 v[106:107], v[114:115]
  v_mov_b64 v[120:121], v[128:129]
  v_mov_b64 v[122:123], v[130:131]
  v_mov_b64 v[112:113], v[152:153]
  v_mov_b64 v[114:115], v[154:155]
  v_mov_b64 v[128:129], v[156:157]
  v_mov_b64 v[130:131], v[158:159]
  s_mov_b64 exec, s[90:91]
  v_mov_b64 v[152:153], v[104:105]
  v_mov_b64 v[154:155], v[106:107]
  v_mov_b64 v[156:157], v[112:113]
  v_mov_b64 v[158:159], v[114:115]
  v_mov_b64 v[104:105], v[120:121]
  v_mov_b64 v[106:107], v[122:123]
  v_mov_b64 v[112:113], v[128:129]
  v_mov_b64 v[114:115], v[130:131]
  v_mov_b64 v[120:121], v[152:153]
  v_mov_b64 v[122:123], v[154:155]
  v_mov_b64 v[128:129], v[156:157]
  v_mov_b64 v[130:131], v[158:159]
  s_mov_b64 exec, -1
  v_mov_b32_dpp v112, v112 quad_perm:[1,0,3,2] row_mask:0xf bank_mask:0xf
  v_mov_b32_dpp v113, v113 quad_perm:[1,0,3,2] row_mask:0xf bank_mask:0xf
  v_mov_b32_dpp v114, v114 quad_perm:[1,0,3,2] row_mask:0xf bank_mask:0xf
  v_mov_b32_dpp v115, v115 quad_perm:[1,0,3,2] row_mask:0xf bank_mask:0xf
  v_mov_b32_dpp v120, v120 quad_perm:[2,3,0,1] row_mask:0xf bank_mask:0xf
  v_mov_b32_dpp v121, v121 quad_perm:[2,3,0,1] row_mask:0xf bank_mask:0xf
  v_mov_b32_dpp v122, v122 quad_perm:[2,3,0,1] row_mask:0xf bank_mask:0xf
  v_mov_b32_dpp v123, v123 quad_perm:[2,3,0,1] row_mask:0xf bank_mask:0xf
  v_mov_b32_dpp v128, v128 quad_perm:[3,2,1,0] row_mask:0xf bank_mask:0xf
  v_mov_b32_dpp v129, v129 quad_perm:[3,2,1,0] row_mask:0xf bank_mask:0xf
  v_mov_b32_dpp v130, v130 quad_perm:[3,2,1,0] row_mask:0xf bank_mask:0xf
  v_mov_b32_dpp v131, v131 quad_perm:[3,2,1,0] row_mask:0xf bank_mask:0xf
  s_waitcnt vmcnt(15)
  v_mov_b32 v152, v132
  s_mov_b64 exec, s[14:15]
  v_mov_b64 v[152:153], v[108:109]
  v_mov_b64 v[154:155], v[110:111]
  v_mov_b64 v[156:157], v[124:125]
  v_mov_b64 v[158:159], v[126:127]
  v_mov_b64 v[108:109], v[116:117]
  v_mov_b64 v[110:111], v[118:119]
  v_mov_b64 v[124:125], v[132:133]
  v_mov_b64 v[126:127], v[134:135]
  v_mov_b64 v[116:117], v[152:153]
  v_mov_b64 v[118:119], v[154:155]
  v_mov_b64 v[132:133], v[156:157]
  v_mov_b64 v[134:135], v[158:159]
  s_mov_b64 exec, s[90:91]
  v_mov_b64 v[152:153], v[108:109]
  v_mov_b64 v[154:155], v[110:111]
  v_mov_b64 v[156:157], v[116:117]
  v_mov_b64 v[158:159], v[118:119]
  v_mov_b64 v[108:109], v[124:125]
  v_mov_b64 v[110:111], v[126:127]
  v_mov_b64 v[116:117], v[132:133]
  v_mov_b64 v[118:119], v[134:135]
  v_mov_b64 v[124:125], v[152:153]
  v_mov_b64 v[126:127], v[154:155]
  v_mov_b64 v[132:133], v[156:157]
  v_mov_b64 v[134:135], v[158:159]
  s_mov_b64 exec, -1
  v_mov_b32_dpp v116, v116 quad_perm:[1,0,3,2] row_mask:0xf bank_mask:0xf
  v_mov_b32_dpp v117, v117 quad_perm:[1,0,3,2] row_mask:0xf bank_mask:0xf
  v_mov_b32_dpp v118, v118 quad_perm:[1,0,3,2] row_mask:0xf bank_mask:0xf
  v_mov_b32_dpp v119, v119 quad_perm:[1,0,3,2] row_mask:0xf bank_mask:0xf
  v_mov_b32_dpp v124, v124 quad_perm:[2,3,0,1] row_mask:0xf bank_mask:0xf
  v_mov_b32_dpp v125, v125 quad_perm:[2,3,0,1] row_mask:0xf bank_mask:0xf
  v_mov_b32_dpp v126, v126 quad_perm:[2,3,0,1] row_mask:0xf bank_mask:0xf
  v_mov_b32_dpp v127, v127 quad_perm:[2,3,0,1] row_mask:0xf bank_mask:0xf
  v_mov_b32_dpp v132, v132 quad_perm:[3,2,1,0] row_mask:0xf bank_mask:0xf
  v_mov_b32_dpp v133, v133 quad_perm:[3,2,1,0] row_mask:0xf bank_mask:0xf
  v_mov_b32_dpp v134, v134 quad_perm:[3,2,1,0] row_mask:0xf bank_mask:0xf
  v_mov_b32_dpp v135, v135 quad_perm:[3,2,1,0] row_mask:0xf bank_mask:0xf
  s_waitcnt vmcnt(11)
  v_mov_b32 v152, v148
  s_mov_b64 exec, s[14:15]
  v_mov_b64 v[152:153], v[136:137]
  v_mov_b64 v[154:155], v[138:139]
  v_mov_b64 v[156:157], v[140:141]
  v_mov_b64 v[158:159], v[142:143]
  v_mov_b64 v[136:137], v[144:145]
  v_mov_b64 v[138:139], v[146:147]
  v_mov_b64 v[140:141], v[148:149]
  v_mov_b64 v[142:143], v[150:151]
  v_mov_b64 v[144:145], v[152:153]
  v_mov_b64 v[146:147], v[154:155]
  v_mov_b64 v[148:149], v[156:157]
  v_mov_b64 v[150:151], v[158:159]
  s_mov_b64 exec, s[90:91]
  v_mov_b64 v[152:153], v[136:137]
  v_mov_b64 v[154:155], v[138:139]
  v_mov_b64 v[156:157], v[144:145]
  v_mov_b64 v[158:159], v[146:147]
  v_mov_b64 v[136:137], v[140:141]
  v_mov_b64 v[138:139], v[142:143]
  v_mov_b64 v[144:145], v[148:149]
  v_mov_b64 v[146:147], v[150:151]
  v_mov_b64 v[140:141], v[152:153]
  v_mov_b64 v[142:143], v[154:155]
  v_mov_b64 v[148:149], v[156:157]
  v_mov_b64 v[150:151], v[158:159]
  s_mov_b64 exec, -1
  v_mov_b32_dpp v144, v144 quad_perm:[1,0,3,2] row_mask:0xf bank_mask:0xf
  v_mov_b32_dpp v145, v145 quad_perm:[1,0,3,2] row_mask:0xf bank_mask:0xf
  v_mov_b32_dpp v146, v146 quad_perm:[1,0,3,2] row_mask:0xf bank_mask:0xf
  v_mov_b32_dpp v147, v147 quad_perm:[1,0,3,2] row_mask:0xf bank_mask:0xf
  v_mov_b32_dpp v140, v140 quad_perm:[2,3,0,1] row_mask:0xf bank_mask:0xf
  v_mov_b32_dpp v141, v141 quad_perm:[2,3,0,1] row_mask:0xf bank_mask:0xf
  v_mov_b32_dpp v142, v142 quad_perm:[2,3,0,1] row_mask:0xf bank_mask:0xf
  v_mov_b32_dpp v143, v143 quad_perm:[2,3,0,1] row_mask:0xf bank_mask:0xf
  v_mov_b32_dpp v148, v148 quad_perm:[3,2,1,0] row_mask:0xf bank_mask:0xf
  v_mov_b32_dpp v149, v149 quad_perm:[3,2,1,0] row_mask:0xf bank_mask:0xf
  v_mov_b32_dpp v150, v150 quad_perm:[3,2,1,0] row_mask:0xf bank_mask:0xf
  v_mov_b32_dpp v151, v151 quad_perm:[3,2,1,0] row_mask:0xf bank_mask:0xf
  v_permlane32_swap_b32 v136, v140
  v_permlane32_swap_b32 v137, v141
  v_permlane32_swap_b32 v138, v142
  v_permlane32_swap_b32 v139, v143
  v_permlane32_swap_b32 v144, v148
  v_permlane32_swap_b32 v145, v149
  v_permlane32_swap_b32 v146, v150
  v_permlane32_swap_b32 v147, v151
  s_mul_i32 s72, s67, 36864
  s_add_u32 s72, s72, 1572864
  s_lshl_b32 s71, s68, 1
  s_add_u32 s71, s71, s61
  s_and_b32 s71, s71, 7
  s_lshl_b32 s71, s71, 12
  s_add_u32 s80, s71, s72
  s_xor_b32 s71, s71, 0x4000
  s_add_u32 s81, s71, s72
  s_add_u32 s72, s72, s73
  s_add_u32 s82, s72, 32768
  v_mov_b32 v234, 1069066811
  v_mov_b32 v235, 3216550459
  v_mul_u32_u24 v5, 144, v2
  s_waitcnt vmcnt(10)
  v_lshlrev_b32 v6, 5, v3
  v_add3_u32 v236, v5, v6, s64
  v_mul_u32_u24 v5, 40, v2
  v_lshlrev_b32 v6, 3, v3
  v_add3_u32 v253, v5, v6, s64
  v_lshrrev_b32 v5, 2, v1
  v_mul_u32_u24 v7, 144, v5
  v_and_b32 v6, 3, v1
  v_lshl_add_u32 v237, v6, 5, v7
  v_mul_u32_u24 v7, 40, v5
  v_lshl_add_u32 v7, v6, 3, v7
  v_add_u32 v0, 4608, v7
  v_and_b32 v5, 7, v1
  v_lshl_add_u32 v5, v3, 3, v5
  v_and_b32 v6, 1, v1
  v_bfe_u32 v7, v1, 2, 1
  v_lshl_add_u32 v6, v7, 1, v6
  v_lshl_add_u32 v6, v3, 2, v6
  s_cmp_eq_u32 s61, 2
  s_cselect_b64 vcc, -1, 0
  v_cndmask_b32 v5, v5, v6, vcc
  v_lshlrev_b32 v238, 4, v5
  s_lshl_b32 s71, s67, 16
  s_add_u32 s71, s71, 7864320
  s_add_u32 s85, s71, s73
  s_lshl_b32 s72, s66, 12
  s_add_u32 s71, s71, s72
  s_mul_i32 s72, s61, 1536
  s_add_u32 s84, s71, s72
  v_and_b32 v5, 7, v1
  v_bfe_u32 v6, v1, 3, 2
  v_lshl_add_u32 v5, v6, 4, v5
  v_bfe_u32 v6, v1, 4, 1
  v_lshl_add_u32 v5, v6, 3, v5
  v_lshlrev_b32 v5, 4, v5
  v_lshrrev_b32 v6, 5, v1
  v_lshl_add_u32 v6, s61, 1, v6
  v_lshl_add_u32 v5, v6, 10, v5
  v_cmp_lt_u32 vcc, 2, v6
  v_mov_b32 v7, 25600
  v_mov_b32 v6, 8192
  v_cndmask_b32 v6, v6, v7, vcc
  v_add_u32 v5, v5, v6
  v_and_b32 v6, 1, v1
  v_bfe_u32 v7, v1, 1, 1
  v_lshl_add_u32 v6, v7, 2, v6
  v_bfe_u32 v7, v1, 3, 1
  v_lshl_add_u32 v6, v7, 3, v6
  v_add_u32 v6, 2, v6
  v_bfe_u32 v7, v1, 2, 2
  v_lshl_add_u32 v6, v7, 4, v6
  v_lshlrev_b32 v6, 4, v6
  v_lshl_add_u32 v6, v3, 10, v6
  v_add_u32 v6, 69632, v6
  s_cmp_eq_u32 s61, 3
  s_cselect_b64 vcc, -1, 0
  v_cndmask_b32 v233, v5, v6, vcc
  v_min_u32 v5, 752, v4
  v_cndmask_b32 v239, v4, v5, vcc
  s_lshl_b32 s71, s66, 2
  s_add_u32 s71, s71, s61
  s_lshl_b32 s71, s71, 4
  s_add_u32 s71, s71, s67
  s_mul_i32 s71, s71, 3072
  s_add_u32 s86, s71, 9043968
  v_mov_b32 v7, 1.0
  s_waitcnt vmcnt(5)
  s_barrier
  ds_read_b128 v[192:195], v4 offset:8192
  ds_read_b128 v[196:199], v4 offset:9216
  ds_read_b128 v[208:211], v232 offset:0
  ds_read_b128 v[200:203], v4 offset:10240
  ds_read_b128 v[204:207], v4 offset:11264
  s_waitcnt lgkmcnt(0)
  v_mfma_f32_16x16x32_bf16 v[152:155], v[192:195], v[8:11], 0
  ds_read_b128 v[212:215], v4 offset:28672
  v_mfma_f32_16x16x32_bf16 v[156:159], v[192:195], v[12:15], 0
  ds_read_b128 v[216:219], v4 offset:29696
  v_mfma_f32_16x16x32_bf16 v[160:163], v[196:199], v[8:11], 0
  ds_read_b128 v[228:231], v232 offset:20480
  v_mfma_f32_16x16x32_bf16 v[164:167], v[196:199], v[12:15], 0
  ds_read_b128 v[220:223], v4 offset:30720
  v_mfma_f32_16x16x32_bf16 v[184:187], v[208:211], v[8:11], 0
  ds_read_b128 v[224:227], v4 offset:31744
  v_mfma_f32_16x16x32_bf16 v[188:191], v[208:211], v[12:15], 0
  s_mov_b32 m0, s64
  s_mov_b32 exec_hi, 0xffff
  buffer_load_dwordx4 v248, s[44:47], 0 offen offset:1536 sc1 lds
  s_mov_b32 exec_hi, -1
  s_add_u32 m0, s64, 16384
  v_mfma_f32_16x16x32_bf16 v[168:171], v[8:11], v[200:203], 0
  buffer_load_dwordx4 v4, s[44:47], s77 offen offset:0 sc1 lds
  v_mfma_f32_16x16x32_bf16 v[172:175], v[12:15], v[200:203], 0
  buffer_load_dwordx4 v4, s[44:47], s77 offen offset:1024 sc1 lds
  v_mfma_f32_16x16x32_bf16 v[176:179], v[8:11], v[204:207], 0
  buffer_load_dwordx4 v4, s[44:47], s77 offen offset:2048 sc1 lds
  v_mfma_f32_16x16x32_bf16 v[180:183], v[12:15], v[204:207], 0
  buffer_load_dwordx4 v4, s[44:47], s77 offen offset:3072 sc1 lds
  s_waitcnt lgkmcnt(0)
  v_mfma_f32_16x16x32_bf16 v[152:155], v[212:215], v[16:19], v[152:155]
  ds_read_b128 v[192:195], v252 offset:8192
  v_mfma_f32_16x16x32_bf16 v[156:159], v[212:215], v[20:23], v[156:159]
  ds_read_b128 v[196:199], v252 offset:9216
  v_mfma_f32_16x16x32_bf16 v[160:163], v[216:219], v[16:19], v[160:163]
  ds_read_b128 v[208:211], v232 offset:40960
  v_mfma_f32_16x16x32_bf16 v[164:167], v[216:219], v[20:23], v[164:167]
  ds_read_b128 v[200:203], v252 offset:10240
  v_mfma_f32_16x16x32_bf16 v[184:187], v[228:231], v[16:19], v[184:187]
  ds_read_b128 v[204:207], v252 offset:11264
  v_mfma_f32_16x16x32_bf16 v[188:191], v[228:231], v[20:23], v[188:191]
  s_mov_b32 m0, s64
  s_mov_b32 exec_hi, 0xffff
  buffer_load_dwordx4 v249, s[44:47], 0 offen offset:2304 sc1 lds
  s_mov_b32 exec_hi, -1
  s_add_u32 m0, s64, 4096
  v_mfma_f32_16x16x32_bf16 v[168:171], v[16:19], v[220:223], v[168:171]
  buffer_load_dwordx4 v4, s[44:47], s78 offen offset:0 sc1 lds
  v_mfma_f32_16x16x32_bf16 v[172:175], v[20:23], v[220:223], v[172:175]
  buffer_load_dwordx4 v4, s[44:47], s78 offen offset:1024 sc1 lds
  v_mfma_f32_16x16x32_bf16 v[176:179], v[16:19], v[224:227], v[176:179]
  buffer_load_dwordx4 v4, s[44:47], s78 offen offset:2048 sc1 lds
  v_mfma_f32_16x16x32_bf16 v[180:183], v[20:23], v[224:227], v[180:183]
  buffer_load_dwordx4 v4, s[44:47], s78 offen offset:3072 sc1 lds
  s_waitcnt lgkmcnt(0)
  v_mfma_f32_16x16x32_bf16 v[152:155], v[192:195], v[24:27], v[152:155]
  ds_read_b128 v[212:215], v252 offset:28672
  v_mfma_f32_16x16x32_bf16 v[156:159], v[192:195], v[28:31], v[156:159]
  ds_read_b128 v[216:219], v252 offset:29696
  v_mfma_f32_16x16x32_bf16 v[160:163], v[196:199], v[24:27], v[160:163]
  ds_read_b128 v[228:231], v232 offset:61440
  v_mfma_f32_16x16x32_bf16 v[164:167], v[196:199], v[28:31], v[164:167]
  ds_read_b128 v[220:223], v252 offset:30720
  v_mfma_f32_16x16x32_bf16 v[184:187], v[208:211], v[24:27], v[184:187]
  ds_read_b128 v[224:227], v252 offset:31744
  v_mfma_f32_16x16x32_bf16 v[188:191], v[208:211], v[28:31], v[188:191]
  v_mfma_f32_16x16x32_bf16 v[168:171], v[24:27], v[200:203], v[168:171]
  v_mfma_f32_16x16x32_bf16 v[172:175], v[28:31], v[200:203], v[172:175]
  v_mfma_f32_16x16x32_bf16 v[176:179], v[24:27], v[204:207], v[176:179]
  v_mfma_f32_16x16x32_bf16 v[180:183], v[28:31], v[204:207], v[180:183]
  s_waitcnt lgkmcnt(0)
  v_mfma_f32_16x16x32_bf16 v[152:155], v[212:215], v[32:35], v[152:155]
  s_waitcnt vmcnt(10)
  s_barrier
  v_mfma_f32_16x16x32_bf16 v[156:159], v[212:215], v[36:39], v[156:159]
  ds_read_b128 v[192:195], v4 offset:12288
  v_mfma_f32_16x16x32_bf16 v[160:163], v[216:219], v[32:35], v[160:163]
  ds_read_b128 v[196:199], v4 offset:13312
  v_mfma_f32_16x16x32_bf16 v[164:167], v[216:219], v[36:39], v[164:167]
  ds_read_b128 v[208:211], v232 offset:768
  v_mfma_f32_16x16x32_bf16 v[184:187], v[228:231], v[32:35], v[184:187]
  ds_read_b128 v[200:203], v4 offset:14336
  v_mfma_f32_16x16x32_bf16 v[188:191], v[228:231], v[36:39], v[188:191]
  ds_read_b128 v[204:207], v4 offset:15360
  v_mfma_f32_16x16x32_bf16 v[168:171], v[32:35], v[220:223], v[168:171]
  v_mfma_f32_16x16x32_bf16 v[172:175], v[36:39], v[220:223], v[172:175]
  v_mfma_f32_16x16x32_bf16 v[176:179], v[32:35], v[224:227], v[176:179]
  v_mfma_f32_16x16x32_bf16 v[180:183], v[36:39], v[224:227], v[180:183]
  s_waitcnt lgkmcnt(0)
  v_mfma_f32_16x16x32_bf16 v[152:155], v[192:195], v[40:43], v[152:155]
  ds_read_b128 v[212:215], v4 offset:32768
  v_mfma_f32_16x16x32_bf16 v[156:159], v[192:195], v[44:47], v[156:159]
  ds_read_b128 v[216:219], v4 offset:33792
  v_mfma_f32_16x16x32_bf16 v[160:163], v[196:199], v[40:43], v[160:163]
  ds_read_b128 v[228:231], v232 offset:21248
  v_mfma_f32_16x16x32_bf16 v[164:167], v[196:199], v[44:47], v[164:167]
  ds_read_b128 v[220:223], v4 offset:34816
  v_mfma_f32_16x16x32_bf16 v[184:187], v[208:211], v[40:43], v[184:187]
  ds_read_b128 v[224:227], v4 offset:35840
  v_mfma_f32_16x16x32_bf16 v[188:191], v[208:211], v[44:47], v[188:191]
  s_mov_b32 m0, s64
  s_mov_b32 exec_hi, 0xffff
  buffer_load_dwordx4 v250, s[44:47], 0 offen offset:3072 sc1 lds
  s_mov_b32 exec_hi, -1
  s_add_u32 m0, s64, 8192
  v_mfma_f32_16x16x32_bf16 v[168:171], v[40:43], v[200:203], v[168:171]
  buffer_load_dwordx4 v4, s[44:47], s79 offen offset:0 sc1 lds
  v_mfma_f32_16x16x32_bf16 v[172:175], v[44:47], v[200:203], v[172:175]
  buffer_load_dwordx4 v4, s[44:47], s79 offen offset:1024 sc1 lds
  v_mfma_f32_16x16x32_bf16 v[176:179], v[40:43], v[204:207], v[176:179]
  buffer_load_dwordx4 v4, s[44:47], s79 offen offset:2048 sc1 lds
  v_mfma_f32_16x16x32_bf16 v[180:183], v[44:47], v[204:207], v[180:183]
  buffer_load_dwordx4 v4, s[44:47], s79 offen offset:3072 sc1 lds
  s_waitcnt lgkmcnt(0)
  v_mfma_f32_16x16x32_bf16 v[152:155], v[212:215], v[48:51], v[152:155]
  ds_read_b128 v[192:195], v252 offset:12288
  v_mfma_f32_16x16x32_bf16 v[156:159], v[212:215], v[52:55], v[156:159]
  ds_read_b128 v[196:199], v252 offset:13312
  v_mfma_f32_16x16x32_bf16 v[160:163], v[216:219], v[48:51], v[160:163]
  ds_read_b128 v[208:211], v232 offset:41728
  v_mfma_f32_16x16x32_bf16 v[164:167], v[216:219], v[52:55], v[164:167]
  ds_read_b128 v[200:203], v252 offset:14336
  v_mfma_f32_16x16x32_bf16 v[184:187], v[228:231], v[48:51], v[184:187]
  ds_read_b128 v[204:207], v252 offset:15360
  v_mfma_f32_16x16x32_bf16 v[188:191], v[228:231], v[52:55], v[188:191]
  v_mfma_f32_16x16x32_bf16 v[168:171], v[48:51], v[220:223], v[168:171]
  v_mfma_f32_16x16x32_bf16 v[172:175], v[52:55], v[220:223], v[172:175]
  v_mfma_f32_16x16x32_bf16 v[176:179], v[48:51], v[224:227], v[176:179]
  v_mfma_f32_16x16x32_bf16 v[180:183], v[52:55], v[224:227], v[180:183]
  s_waitcnt lgkmcnt(0)
  v_mfma_f32_16x16x32_bf16 v[152:155], v[192:195], v[56:59], v[152:155]
  ds_read_b128 v[212:215], v252 offset:32768
  v_mfma_f32_16x16x32_bf16 v[156:159], v[192:195], v[60:63], v[156:159]
  ds_read_b128 v[216:219], v252 offset:33792
  v_mfma_f32_16x16x32_bf16 v[160:163], v[196:199], v[56:59], v[160:163]
  ds_read_b128 v[228:231], v232 offset:62208
  v_mfma_f32_16x16x32_bf16 v[164:167], v[196:199], v[60:63], v[164:167]
  ds_read_b128 v[220:223], v252 offset:34816
  v_mfma_f32_16x16x32_bf16 v[184:187], v[208:211], v[56:59], v[184:187]
  ds_read_b128 v[224:227], v252 offset:35840
  v_mfma_f32_16x16x32_bf16 v[188:191], v[208:211], v[60:63], v[188:191]
  v_mfma_f32_16x16x32_bf16 v[168:171], v[56:59], v[200:203], v[168:171]
  v_mfma_f32_16x16x32_bf16 v[172:175], v[60:63], v[200:203], v[172:175]
  v_mfma_f32_16x16x32_bf16 v[176:179], v[56:59], v[204:207], v[176:179]
  v_mfma_f32_16x16x32_bf16 v[180:183], v[60:63], v[204:207], v[180:183]
  s_waitcnt lgkmcnt(0)
  v_mfma_f32_16x16x32_bf16 v[152:155], v[212:215], v[64:67], v[152:155]
  s_waitcnt vmcnt(10)
  s_barrier
  v_mfma_f32_16x16x32_bf16 v[156:159], v[212:215], v[68:71], v[156:159]
  ds_read_b128 v[192:195], v4 offset:16384
  v_mfma_f32_16x16x32_bf16 v[160:163], v[216:219], v[64:67], v[160:163]
  ds_read_b128 v[196:199], v4 offset:17408
  v_mfma_f32_16x16x32_bf16 v[164:167], v[216:219], v[68:71], v[164:167]
  ds_read_b128 v[208:211], v232 offset:1536
  v_mfma_f32_16x16x32_bf16 v[184:187], v[228:231], v[64:67], v[184:187]
  ds_read_b128 v[200:203], v4 offset:18432
  v_mfma_f32_16x16x32_bf16 v[188:191], v[228:231], v[68:71], v[188:191]
  ds_read_b128 v[204:207], v4 offset:19456
  v_mfma_f32_16x16x32_bf16 v[168:171], v[64:67], v[220:223], v[168:171]
  v_mfma_f32_16x16x32_bf16 v[172:175], v[68:71], v[220:223], v[172:175]
  v_mfma_f32_16x16x32_bf16 v[176:179], v[64:67], v[224:227], v[176:179]
  v_mfma_f32_16x16x32_bf16 v[180:183], v[68:71], v[224:227], v[180:183]
  s_waitcnt lgkmcnt(0)
  v_mfma_f32_16x16x32_bf16 v[152:155], v[192:195], v[72:75], v[152:155]
  ds_read_b128 v[212:215], v4 offset:36864
  v_mfma_f32_16x16x32_bf16 v[156:159], v[192:195], v[76:79], v[156:159]
  ds_read_b128 v[216:219], v4 offset:37888
  v_mfma_f32_16x16x32_bf16 v[160:163], v[196:199], v[72:75], v[160:163]
  ds_read_b128 v[228:231], v232 offset:22016
  v_mfma_f32_16x16x32_bf16 v[164:167], v[196:199], v[76:79], v[164:167]
  ds_read_b128 v[220:223], v4 offset:38912
  v_mfma_f32_16x16x32_bf16 v[184:187], v[208:211], v[72:75], v[184:187]
  ds_read_b128 v[224:227], v4 offset:39936
  v_mfma_f32_16x16x32_bf16 v[188:191], v[208:211], v[76:79], v[188:191]
  s_add_u32 m0, s64, 12288
  v_mfma_f32_16x16x32_bf16 v[168:171], v[72:75], v[200:203], v[168:171]
  buffer_load_dwordx4 v4, s[44:47], s80 offen offset:0 sc1 lds
  v_mfma_f32_16x16x32_bf16 v[172:175], v[76:79], v[200:203], v[172:175]
  buffer_load_dwordx4 v4, s[44:47], s80 offen offset:1024 sc1 lds
  v_mfma_f32_16x16x32_bf16 v[176:179], v[72:75], v[204:207], v[176:179]
  buffer_load_dwordx4 v4, s[44:47], s80 offen offset:2048 sc1 lds
  v_mfma_f32_16x16x32_bf16 v[180:183], v[76:79], v[204:207], v[180:183]
  buffer_load_dwordx4 v4, s[44:47], s80 offen offset:3072 sc1 lds
  s_waitcnt lgkmcnt(0)
  v_mfma_f32_16x16x32_bf16 v[152:155], v[212:215], v[80:83], v[152:155]
  ds_read_b128 v[192:195], v252 offset:16384
  v_mfma_f32_16x16x32_bf16 v[156:159], v[212:215], v[84:87], v[156:159]
  ds_read_b128 v[196:199], v252 offset:17408
  v_mfma_f32_16x16x32_bf16 v[160:163], v[216:219], v[80:83], v[160:163]
  ds_read_b128 v[208:211], v232 offset:42496
  v_mfma_f32_16x16x32_bf16 v[164:167], v[216:219], v[84:87], v[164:167]
  ds_read_b128 v[200:203], v252 offset:18432
  v_mfma_f32_16x16x32_bf16 v[184:187], v[228:231], v[80:83], v[184:187]
  ds_read_b128 v[204:207], v252 offset:19456
  v_mfma_f32_16x16x32_bf16 v[188:191], v[228:231], v[84:87], v[188:191]
  v_mfma_f32_16x16x32_bf16 v[168:171], v[80:83], v[220:223], v[168:171]
  v_mfma_f32_16x16x32_bf16 v[172:175], v[84:87], v[220:223], v[172:175]
  v_mfma_f32_16x16x32_bf16 v[176:179], v[80:83], v[224:227], v[176:179]
  v_mfma_f32_16x16x32_bf16 v[180:183], v[84:87], v[224:227], v[180:183]
  s_waitcnt lgkmcnt(0)
  v_mfma_f32_16x16x32_bf16 v[152:155], v[192:195], v[88:91], v[152:155]
  ds_read_b128 v[212:215], v252 offset:36864
  v_mfma_f32_16x16x32_bf16 v[156:159], v[192:195], v[92:95], v[156:159]
  ds_read_b128 v[216:219], v252 offset:37888
  v_mfma_f32_16x16x32_bf16 v[160:163], v[196:199], v[88:91], v[160:163]
  ds_read_b128 v[228:231], v232 offset:62976
  v_mfma_f32_16x16x32_bf16 v[164:167], v[196:199], v[92:95], v[164:167]
  ds_read_b128 v[220:223], v252 offset:38912
  v_mfma_f32_16x16x32_bf16 v[184:187], v[208:211], v[88:91], v[184:187]
  ds_read_b128 v[224:227], v252 offset:39936
  v_mfma_f32_16x16x32_bf16 v[188:191], v[208:211], v[92:95], v[188:191]
  v_mfma_f32_16x16x32_bf16 v[168:171], v[88:91], v[200:203], v[168:171]
  v_mfma_f32_16x16x32_bf16 v[172:175], v[92:95], v[200:203], v[172:175]
  v_mfma_f32_16x16x32_bf16 v[176:179], v[88:91], v[204:207], v[176:179]
  v_mfma_f32_16x16x32_bf16 v[180:183], v[92:95], v[204:207], v[180:183]
  s_waitcnt lgkmcnt(0)
  v_mfma_f32_16x16x32_bf16 v[152:155], v[212:215], v[96:99], v[152:155]
  s_waitcnt vmcnt(9)
  s_barrier
  v_mfma_f32_16x16x32_bf16 v[156:159], v[212:215], v[100:103], v[156:159]
  ds_read_b128 v[192:195], v4 offset:4096
  v_mfma_f32_16x16x32_bf16 v[160:163], v[216:219], v[96:99], v[160:163]
  ds_read_b128 v[196:199], v4 offset:5120
  v_mfma_f32_16x16x32_bf16 v[164:167], v[216:219], v[100:103], v[164:167]
  ds_read_b128 v[208:211], v232 offset:2304
  v_mfma_f32_16x16x32_bf16 v[184:187], v[228:231], v[96:99], v[184:187]
  ds_read_b128 v[200:203], v4 offset:6144
  v_mfma_f32_16x16x32_bf16 v[188:191], v[228:231], v[100:103], v[188:191]
  ds_read_b128 v[204:207], v4 offset:7168
  v_mfma_f32_16x16x32_bf16 v[168:171], v[96:99], v[220:223], v[168:171]
  v_mfma_f32_16x16x32_bf16 v[172:175], v[100:103], v[220:223], v[172:175]
  v_mfma_f32_16x16x32_bf16 v[176:179], v[96:99], v[224:227], v[176:179]
  v_mfma_f32_16x16x32_bf16 v[180:183], v[100:103], v[224:227], v[180:183]
  s_waitcnt lgkmcnt(0)
  v_mfma_f32_16x16x32_bf16 v[152:155], v[192:195], v[104:107], v[152:155]
  ds_read_b128 v[212:215], v4 offset:24576
  v_mfma_f32_16x16x32_bf16 v[156:159], v[192:195], v[108:111], v[156:159]
  ds_read_b128 v[216:219], v4 offset:25600
  v_mfma_f32_16x16x32_bf16 v[160:163], v[196:199], v[104:107], v[160:163]
  ds_read_b128 v[228:231], v232 offset:22784
  v_mfma_f32_16x16x32_bf16 v[164:167], v[196:199], v[108:111], v[164:167]
  ds_read_b128 v[220:223], v4 offset:26624
  v_mfma_f32_16x16x32_bf16 v[184:187], v[208:211], v[104:107], v[184:187]
  ds_read_b128 v[224:227], v4 offset:27648
  v_mfma_f32_16x16x32_bf16 v[188:191], v[208:211], v[108:111], v[188:191]
  s_add_u32 m0, s64, 16384
  v_mfma_f32_16x16x32_bf16 v[168:171], v[104:107], v[200:203], v[168:171]
  buffer_load_dwordx4 v4, s[44:47], s81 offen offset:0 sc1 lds
  v_mfma_f32_16x16x32_bf16 v[172:175], v[108:111], v[200:203], v[172:175]
  buffer_load_dwordx4 v4, s[44:47], s81 offen offset:1024 sc1 lds
  v_mfma_f32_16x16x32_bf16 v[176:179], v[104:107], v[204:207], v[176:179]
  buffer_load_dwordx4 v4, s[44:47], s81 offen offset:2048 sc1 lds
  v_mfma_f32_16x16x32_bf16 v[180:183], v[108:111], v[204:207], v[180:183]
  buffer_load_dwordx4 v4, s[44:47], s81 offen offset:3072 sc1 lds
  s_waitcnt lgkmcnt(0)
  v_mfma_f32_16x16x32_bf16 v[152:155], v[212:215], v[112:115], v[152:155]
  ds_read_b128 v[192:195], v252 offset:4096
  v_mfma_f32_16x16x32_bf16 v[156:159], v[212:215], v[116:119], v[156:159]
  ds_read_b128 v[196:199], v252 offset:5120
  v_mfma_f32_16x16x32_bf16 v[160:163], v[216:219], v[112:115], v[160:163]
  ds_read_b128 v[208:211], v232 offset:43264
  v_mfma_f32_16x16x32_bf16 v[164:167], v[216:219], v[116:119], v[164:167]
  ds_read_b128 v[200:203], v252 offset:6144
  v_mfma_f32_16x16x32_bf16 v[184:187], v[228:231], v[112:115], v[184:187]
  ds_read_b128 v[204:207], v252 offset:7168
  v_mfma_f32_16x16x32_bf16 v[188:191], v[228:231], v[116:119], v[188:191]
  v_mfma_f32_16x16x32_bf16 v[168:171], v[112:115], v[220:223], v[168:171]
  v_mfma_f32_16x16x32_bf16 v[172:175], v[116:119], v[220:223], v[172:175]
  v_mfma_f32_16x16x32_bf16 v[176:179], v[112:115], v[224:227], v[176:179]
  v_mfma_f32_16x16x32_bf16 v[180:183], v[116:119], v[224:227], v[180:183]
  s_waitcnt lgkmcnt(0)
  v_mfma_f32_16x16x32_bf16 v[152:155], v[192:195], v[120:123], v[152:155]
  ds_read_b128 v[212:215], v252 offset:24576
  v_mfma_f32_16x16x32_bf16 v[156:159], v[192:195], v[124:127], v[156:159]
  ds_read_b128 v[216:219], v252 offset:25600
  v_mfma_f32_16x16x32_bf16 v[160:163], v[196:199], v[120:123], v[160:163]
  ds_read_b128 v[228:231], v232 offset:63744
  v_mfma_f32_16x16x32_bf16 v[164:167], v[196:199], v[124:127], v[164:167]
  ds_read_b128 v[220:223], v252 offset:26624
  v_mfma_f32_16x16x32_bf16 v[184:187], v[208:211], v[120:123], v[184:187]
  ds_read_b128 v[224:227], v252 offset:27648
  v_mfma_f32_16x16x32_bf16 v[188:191], v[208:211], v[124:127], v[188:191]
  v_mfma_f32_16x16x32_bf16 v[168:171], v[120:123], v[200:203], v[168:171]
  v_mfma_f32_16x16x32_bf16 v[172:175], v[124:127], v[200:203], v[172:175]
  v_mfma_f32_16x16x32_bf16 v[176:179], v[120:123], v[204:207], v[176:179]
  v_mfma_f32_16x16x32_bf16 v[180:183], v[124:127], v[204:207], v[180:183]
  s_waitcnt lgkmcnt(0)
  v_mfma_f32_16x16x32_bf16 v[152:155], v[212:215], v[128:131], v[152:155]
  s_waitcnt vmcnt(8)
  s_barrier
  v_mfma_f32_16x16x32_bf16 v[156:159], v[212:215], v[132:135], v[156:159]
  ds_read_b128 v[192:195], v4 offset:8192
  v_mfma_f32_16x16x32_bf16 v[160:163], v[216:219], v[128:131], v[160:163]
  ds_read_b128 v[196:199], v4 offset:9216
  v_mfma_f32_16x16x32_bf16 v[164:167], v[216:219], v[132:135], v[164:167]
  ds_read_b128 v[208:211], v232 offset:3072
  v_mfma_f32_16x16x32_bf16 v[184:187], v[228:231], v[128:131], v[184:187]
  ds_read_b128 v[200:203], v4 offset:10240
  v_mfma_f32_16x16x32_bf16 v[188:191], v[228:231], v[132:135], v[188:191]
  ds_read_b128 v[204:207], v4 offset:11264
  v_mfma_f32_16x16x32_bf16 v[168:171], v[128:131], v[220:223], v[168:171]
  v_mfma_f32_16x16x32_bf16 v[172:175], v[132:135], v[220:223], v[172:175]
  v_mfma_f32_16x16x32_bf16 v[176:179], v[128:131], v[224:227], v[176:179]
  v_mfma_f32_16x16x32_bf16 v[180:183], v[132:135], v[224:227], v[180:183]
  s_waitcnt lgkmcnt(0)
  v_mfma_f32_16x16x32_bf16 v[152:155], v[192:195], v[136:139], v[152:155]
  ds_read_b128 v[212:215], v4 offset:28672
  v_mfma_f32_16x16x32_bf16 v[156:159], v[192:195], v[140:143], v[156:159]
  ds_read_b128 v[216:219], v4 offset:29696
  v_mfma_f32_16x16x32_bf16 v[160:163], v[196:199], v[136:139], v[160:163]
  ds_read_b128 v[228:231], v232 offset:23552
  v_mfma_f32_16x16x32_bf16 v[164:167], v[196:199], v[140:143], v[164:167]
  ds_read_b128 v[220:223], v4 offset:30720
  v_mfma_f32_16x16x32_bf16 v[184:187], v[208:211], v[136:139], v[184:187]
  ds_read_b128 v[224:227], v4 offset:31744
  v_mfma_f32_16x16x32_bf16 v[188:191], v[208:211], v[140:143], v[188:191]
  s_add_u32 m0, s73, 49152
  v_mfma_f32_16x16x32_bf16 v[168:171], v[136:139], v[200:203], v[168:171]
  buffer_load_dwordx4 v4, s[44:47], s82 offen sc1 lds
  v_mfma_f32_16x16x32_bf16 v[172:175], v[140:143], v[200:203], v[172:175]
  v_mfma_f32_16x16x32_bf16 v[176:179], v[136:139], v[204:207], v[176:179]
  v_mfma_f32_16x16x32_bf16 v[180:183], v[140:143], v[204:207], v[180:183]
  s_waitcnt lgkmcnt(0)
  v_mfma_f32_16x16x32_bf16 v[152:155], v[212:215], v[144:147], v[152:155]
  v_mfma_f32_16x16x32_bf16 v[156:159], v[212:215], v[148:151], v[156:159]
  v_mfma_f32_16x16x32_bf16 v[160:163], v[216:219], v[144:147], v[160:163]
  v_mfma_f32_16x16x32_bf16 v[164:167], v[216:219], v[148:151], v[164:167]
  v_mfma_f32_16x16x32_bf16 v[184:187], v[228:231], v[144:147], v[184:187]
  v_mfma_f32_16x16x32_bf16 v[188:191], v[228:231], v[148:151], v[188:191]
  v_mfma_f32_16x16x32_bf16 v[168:171], v[144:147], v[220:223], v[168:171]
  v_mfma_f32_16x16x32_bf16 v[172:175], v[148:151], v[220:223], v[172:175]
  v_mfma_f32_16x16x32_bf16 v[176:179], v[144:147], v[224:227], v[176:179]
  v_mfma_f32_16x16x32_bf16 v[180:183], v[148:151], v[224:227], v[180:183]
  v_max3_f32 v228, v152, v153, v154
  v_max3_f32 v229, -v152, -v153, -v154
  v_max3_f32 v230, v156, v157, v158
  v_max3_f32 v231, -v156, -v157, -v158
  v_max3_f32 v228, v228, v155, v160
  v_max3_f32 v229, v229, -v155, -v160
  v_max3_f32 v230, v230, v159, v164
  v_max3_f32 v231, v231, -v159, -v164
  v_max3_f32 v228, v228, v161, v162
  v_max3_f32 v229, v229, -v161, -v162
  v_max3_f32 v230, v230, v165, v166
  v_max3_f32 v231, v231, -v165, -v166
  v_max3_f32 v228, v228, v163, v184
  v_max3_f32 v229, v229, -v163, -v184
  v_max3_f32 v230, v230, v167, v188
  v_max3_f32 v231, v231, -v167, -v188
  v_permlane16_swap_b32 v228, v229
  s_nop 0
  v_permlane16_swap_b32 v230, v231
  v_max_f32 v228, v228, v229
  v_max_f32 v230, v230, v231
  v_mul_f32 v229, v228, v235
  v_mul_f32 v231, v230, v235
  v_mul_f32 v228, v228, v235
  v_mul_f32 v230, v230, v235
  s_nop 0
  v_permlane16_swap_b32 v228, v229
  v_permlane16_swap_b32 v230, v231
  s_barrier
  v_add_u32 v6, s64, v4
  v_cvt_pk_bf16_f32 v168, v168, v169
  v_cvt_pk_bf16_f32 v169, v170, v171
  v_cvt_pk_bf16_f32 v170, v172, v173
  v_cvt_pk_bf16_f32 v171, v174, v175
  ds_write_b128 v6, v[168:171] offset:6144
  v_cvt_pk_bf16_f32 v176, v176, v177
  v_cvt_pk_bf16_f32 v177, v178, v179
  v_cvt_pk_bf16_f32 v178, v180, v181
  v_cvt_pk_bf16_f32 v179, v182, v183
  ds_write_b128 v6, v[176:179] offset:7168
  v_pk_fma_f32 v[192:193], v[152:153], v[234:235], v[228:229] op_sel:[0,0,0] op_sel_hi:[0,1,1]
  v_pk_fma_f32 v[210:211], v[156:157], v[234:235], v[230:231] op_sel:[0,0,0] op_sel_hi:[0,1,1]
  v_pk_fma_f32 v[194:195], v[152:153], v[234:235], v[228:229] op_sel:[1,0,0] op_sel_hi:[1,1,1]
  v_pk_fma_f32 v[212:213], v[156:157], v[234:235], v[230:231] op_sel:[1,0,0] op_sel_hi:[1,1,1]
  v_pk_fma_f32 v[196:197], v[154:155], v[234:235], v[228:229] op_sel:[0,0,0] op_sel_hi:[0,1,1]
  v_pk_fma_f32 v[214:215], v[158:159], v[234:235], v[230:231] op_sel:[0,0,0] op_sel_hi:[0,1,1]
  v_pk_fma_f32 v[198:199], v[154:155], v[234:235], v[228:229] op_sel:[1,0,0] op_sel_hi:[1,1,1]
  v_pk_fma_f32 v[216:217], v[158:159], v[234:235], v[230:231] op_sel:[1,0,0] op_sel_hi:[1,1,1]
  v_pk_fma_f32 v[200:201], v[160:161], v[234:235], v[228:229] op_sel:[0,0,0] op_sel_hi:[0,1,1]
  v_pk_fma_f32 v[218:219], v[164:165], v[234:235], v[230:231] op_sel:[0,0,0] op_sel_hi:[0,1,1]
  v_pk_fma_f32 v[202:203], v[160:161], v[234:235], v[228:229] op_sel:[1,0,0] op_sel_hi:[1,1,1]
  v_pk_fma_f32 v[220:221], v[164:165], v[234:235], v[230:231] op_sel:[1,0,0] op_sel_hi:[1,1,1]
  v_pk_fma_f32 v[204:205], v[162:163], v[234:235], v[228:229] op_sel:[0,0,0] op_sel_hi:[0,1,1]
  v_pk_fma_f32 v[222:223], v[166:167], v[234:235], v[230:231] op_sel:[0,0,0] op_sel_hi:[0,1,1]
  v_pk_fma_f32 v[206:207], v[162:163], v[234:235], v[228:229] op_sel:[1,0,0] op_sel_hi:[1,1,1]
  v_pk_fma_f32 v[224:225], v[166:167], v[234:235], v[230:231] op_sel:[1,0,0] op_sel_hi:[1,1,1]
  v_pk_fma_f32 v[208:209], v[184:185], v[234:235], v[228:229] op_sel:[0,0,0] op_sel_hi:[0,1,1]
  v_pk_fma_f32 v[226:227], v[188:189], v[234:235], v[230:231] op_sel:[0,0,0] op_sel_hi:[0,1,1]
  v_exp_f32 v192, v192
  v_exp_f32 v193, v193
  v_exp_f32 v210, v210
  v_exp_f32 v211, v211
  v_exp_f32 v194, v194
  v_exp_f32 v195, v195
  v_exp_f32 v212, v212
  v_exp_f32 v213, v213
  v_exp_f32 v196, v196
  v_exp_f32 v197, v197
  v_exp_f32 v214, v214
  v_exp_f32 v215, v215
  v_pk_add_f32 v[228:229], v[192:193], v[194:195]
  v_pk_add_f32 v[230:231], v[210:211], v[212:213]
  v_exp_f32 v198, v198
  v_exp_f32 v199, v199
  v_exp_f32 v216, v216
  v_exp_f32 v217, v217
  v_pk_add_f32 v[228:229], v[228:229], v[196:197]
  v_pk_add_f32 v[230:231], v[230:231], v[214:215]
  v_exp_f32 v200, v200
  v_exp_f32 v201, v201
  v_exp_f32 v218, v218
  v_exp_f32 v219, v219
  v_pk_add_f32 v[228:229], v[228:229], v[198:199]
  v_pk_add_f32 v[230:231], v[230:231], v[216:217]
  v_exp_f32 v202, v202
  v_exp_f32 v203, v203
  v_exp_f32 v220, v220
  v_exp_f32 v221, v221
  v_pk_add_f32 v[228:229], v[228:229], v[200:201]
  v_pk_add_f32 v[230:231], v[230:231], v[218:219]
  v_exp_f32 v204, v204
  v_exp_f32 v205, v205
  v_exp_f32 v222, v222
  v_exp_f32 v223, v223
  v_pk_add_f32 v[228:229], v[228:229], v[202:203]
  v_pk_add_f32 v[230:231], v[230:231], v[220:221]
  v_exp_f32 v206, v206
  v_exp_f32 v207, v207
  v_exp_f32 v224, v224
  v_exp_f32 v225, v225
  v_pk_add_f32 v[228:229], v[228:229], v[204:205]
  v_pk_add_f32 v[230:231], v[230:231], v[222:223]
  v_exp_f32 v208, v208
  v_exp_f32 v209, v209
  v_exp_f32 v226, v226
  v_exp_f32 v227, v227
  v_pk_add_f32 v[228:229], v[228:229], v[206:207]
  v_pk_add_f32 v[230:231], v[230:231], v[224:225]
  v_pk_add_f32 v[228:229], v[228:229], v[208:209]
  v_pk_add_f32 v[230:231], v[230:231], v[226:227]
  s_nop 0
  v_permlane16_swap_b32 v228, v229
  v_permlane16_swap_b32 v230, v231
  v_add_f32 v228, v228, v229
  v_add_f32 v230, v230, v231
  v_rcp_f32 v229, v228
  v_rcp_f32 v231, v230
  v_rcp_f32 v228, v228
  v_rcp_f32 v230, v230
  s_nop 1
  v_permlane16_swap_b32 v228, v229
  v_permlane16_swap_b32 v230, v231
  v_pk_mul_f32 v[192:193], v[192:193], v[228:229]
  v_pk_mul_f32 v[210:211], v[210:211], v[230:231]
  v_pk_mul_f32 v[194:195], v[194:195], v[228:229]
  v_pk_mul_f32 v[212:213], v[212:213], v[230:231]
  v_pk_mul_f32 v[196:197], v[196:197], v[228:229]
  v_pk_mul_f32 v[214:215], v[214:215], v[230:231]
  v_pk_mul_f32 v[198:199], v[198:199], v[228:229]
  v_pk_mul_f32 v[216:217], v[216:217], v[230:231]
  v_pk_mul_f32 v[200:201], v[200:201], v[228:229]
  v_pk_mul_f32 v[218:219], v[218:219], v[230:231]
  v_pk_mul_f32 v[202:203], v[202:203], v[228:229]
  v_pk_mul_f32 v[220:221], v[220:221], v[230:231]
  v_pk_mul_f32 v[204:205], v[204:205], v[228:229]
  v_pk_mul_f32 v[222:223], v[222:223], v[230:231]
  v_pk_mul_f32 v[206:207], v[206:207], v[228:229]
  v_pk_mul_f32 v[224:225], v[224:225], v[230:231]
  v_pk_mul_f32 v[208:209], v[208:209], v[228:229]
  v_pk_mul_f32 v[226:227], v[226:227], v[230:231]
  v_cvt_pk_bf16_f32 v152, v192, v193
  v_cvt_pk_bf16_f32 v153, v194, v195
  v_cvt_pk_bf16_f32 v154, v196, v197
  v_cvt_pk_bf16_f32 v155, v198, v199
  v_cvt_pk_bf16_f32 v156, v200, v201
  v_cvt_pk_bf16_f32 v157, v202, v203
  v_cvt_pk_bf16_f32 v158, v204, v205
  v_cvt_pk_bf16_f32 v159, v206, v207
  v_cvt_pk_bf16_f32 v160, v208, v209
  v_cvt_pk_bf16_f32 v161, v185, v7
  ds_write_b128 v236, v[152:155] offset:0
  ds_write_b128 v236, v[156:159] offset:16
  ds_write_b64 v253, v[160:161] offset:4608
  v_cvt_pk_bf16_f32 v240, v210, v211
  v_cvt_pk_bf16_f32 v241, v212, v213
  v_cvt_pk_bf16_f32 v242, v214, v215
  v_cvt_pk_bf16_f32 v243, v216, v217
  v_cvt_pk_bf16_f32 v244, v218, v219
  v_cvt_pk_bf16_f32 v245, v220, v221
  v_cvt_pk_bf16_f32 v246, v222, v223
  v_cvt_pk_bf16_f32 v247, v224, v225
  v_cvt_pk_bf16_f32 v248, v226, v227
  v_cvt_pk_bf16_f32 v249, v189, v7
  ds_write_b128 v236, v[240:243] offset:2304
  ds_write_b128 v236, v[244:247] offset:2320
  ds_write_b64 v253, v[248:249] offset:5248
  s_add_u32 s71, s73, 6144
  v_add_u32 v6, s71, v4
  s_waitcnt vmcnt(0) lgkmcnt(0)
  s_barrier
  s_cmp_eq_u32 s61, 3
  s_cbranch_scc1 L_Bq
  s_cmp_eq_u32 s61, 2
  s_cbranch_scc1 L_Bk2
  ds_read_b128 v[172:175], v6 offset:0
  ds_read_b128 v[176:179], v6 offset:20480
  ds_read_b128 v[224:227], v6 offset:40960
  ds_read_b128 v[228:231], v6 offset:61440
  ds_read_b64_tr_b16 v[192:193], v237 offset:0
  ds_read_b64_tr_b16 v[194:195], v237 offset:2304
  ds_read_b64_tr_b16 v[196:197], v237 offset:20480
  ds_read_b64_tr_b16 v[198:199], v237 offset:22784
  ds_read_b64_tr_b16 v[200:201], v237 offset:40960
  ds_read_b64_tr_b16 v[202:203], v237 offset:43264
  ds_read_b64_tr_b16 v[204:205], v237 offset:61440
  ds_read_b64_tr_b16 v[206:207], v237 offset:63744
  v_mov_b32 v243, s60
  v_mov_b32 v247, s60
  v_mov_b32 v251, s60
  s_mov_b32 s90, 0x07060100
  s_mov_b32 s14, 0x00ff00ff
  s_mov_b32 s15, 0xff00ff00
  s_waitcnt lgkmcnt(6)
  v_mfma_f32_16x16x32_bf16 v[152:155], v[192:195], v[172:175], 0
  ds_read_b64_tr_b16 v[208:209], v237 offset:8
  ds_read_b64_tr_b16 v[210:211], v237 offset:2312
  s_waitcnt lgkmcnt(6)
  v_mfma_f32_16x16x32_bf16 v[152:155], v[196:199], v[176:179], v[152:155]
  ds_read_b64_tr_b16 v[212:213], v237 offset:20488
  ds_read_b64_tr_b16 v[214:215], v237 offset:22792
  s_waitcnt lgkmcnt(6)
  v_mfma_f32_16x16x32_bf16 v[152:155], v[200:203], v[224:227], v[152:155]
  ds_read_b64_tr_b16 v[216:217], v237 offset:40968
  ds_read_b64_tr_b16 v[218:219], v237 offset:43272
  s_waitcnt lgkmcnt(6)
  v_mfma_f32_16x16x32_bf16 v[152:155], v[204:207], v[228:231], v[152:155]
  ds_read_b64_tr_b16 v[220:221], v237 offset:61448
  ds_read_b64_tr_b16 v[222:223], v237 offset:63752
  s_waitcnt lgkmcnt(6)
  v_mfma_f32_16x16x32_bf16 v[156:159], v[208:211], v[172:175], 0
  ds_read_b64_tr_b16 v[192:193], v237 offset:16
  ds_read_b64_tr_b16 v[194:195], v237 offset:2320
  s_waitcnt lgkmcnt(6)
  v_mfma_f32_16x16x32_bf16 v[156:159], v[212:215], v[176:179], v[156:159]
  ds_read_b64_tr_b16 v[196:197], v237 offset:20496
  ds_read_b64_tr_b16 v[198:199], v237 offset:22800
  s_waitcnt lgkmcnt(6)
  v_mfma_f32_16x16x32_bf16 v[156:159], v[216:219], v[224:227], v[156:159]
  ds_read_b64_tr_b16 v[200:201], v237 offset:40976
  ds_read_b64_tr_b16 v[202:203], v237 offset:43280
  s_waitcnt lgkmcnt(6)
  v_mfma_f32_16x16x32_bf16 v[156:159], v[220:223], v[228:231], v[156:159]
  ds_read_b64_tr_b16 v[204:205], v237 offset:61456
  ds_read_b64_tr_b16 v[206:207], v237 offset:63760
  s_waitcnt lgkmcnt(6)
  v_mfma_f32_16x16x32_bf16 v[160:163], v[192:195], v[172:175], 0
  ds_read_b64_tr_b16 v[208:209], v237 offset:24
  ds_read_b64_tr_b16 v[210:211], v237 offset:2328
  s_waitcnt lgkmcnt(6)
  v_mfma_f32_16x16x32_bf16 v[160:163], v[196:199], v[176:179], v[160:163]
  ds_read_b64_tr_b16 v[212:213], v237 offset:20504
  ds_read_b64_tr_b16 v[214:215], v237 offset:22808
  s_waitcnt lgkmcnt(6)
  v_mfma_f32_16x16x32_bf16 v[160:163], v[200:203], v[224:227], v[160:163]
  ds_read_b64_tr_b16 v[216:217], v237 offset:40984
  ds_read_b64_tr_b16 v[218:219], v237 offset:43288
  s_waitcnt lgkmcnt(6)
  v_mfma_f32_16x16x32_bf16 v[160:163], v[204:207], v[228:231], v[160:163]
  ds_read_b64_tr_b16 v[220:221], v237 offset:61464
  ds_read_b64_tr_b16 v[222:223], v237 offset:63768
  v_cvt_pk_bf16_f32 v240, v152, v152
  v_perm_b32 v240, v153, v240, s90
  v_cvt_pk_bf16_f32 v241, v154, v154
  v_perm_b32 v241, v155, v241, s90
  v_cvt_pk_bf16_f32 v242, v156, v156
  v_perm_b32 v242, v157, v242, s90
  s_mov_b64 exec, s[14:15]
  buffer_store_dwordx4 v[240:243], v238, s[44:47], s84 offen offset:0 sc1
  s_mov_b64 exec, -1
  s_waitcnt lgkmcnt(6)
  v_mfma_f32_16x16x32_bf16 v[164:167], v[208:211], v[172:175], 0
  ds_read_b64_tr_b16 v[192:193], v0 offset:0
  ds_read_b64_tr_b16 v[194:195], v0 offset:640
  s_waitcnt lgkmcnt(6)
  v_mfma_f32_16x16x32_bf16 v[164:167], v[212:215], v[176:179], v[164:167]
  ds_read_b64_tr_b16 v[196:197], v0 offset:20480
  ds_read_b64_tr_b16 v[198:199], v0 offset:21120
  s_waitcnt lgkmcnt(6)
  v_mfma_f32_16x16x32_bf16 v[164:167], v[216:219], v[224:227], v[164:167]
  ds_read_b64_tr_b16 v[200:201], v0 offset:40960
  ds_read_b64_tr_b16 v[202:203], v0 offset:41600
  s_waitcnt lgkmcnt(6)
  v_mfma_f32_16x16x32_bf16 v[164:167], v[220:223], v[228:231], v[164:167]
  ds_read_b64_tr_b16 v[204:205], v0 offset:61440
  ds_read_b64_tr_b16 v[206:207], v0 offset:62080
  v_cvt_pk_bf16_f32 v244, v158, v158
  v_perm_b32 v244, v159, v244, s90
  v_cvt_pk_bf16_f32 v245, v160, v160
  v_perm_b32 v245, v161, v245, s90
  v_cvt_pk_bf16_f32 v246, v162, v162
  v_perm_b32 v246, v163, v246, s90
  s_mov_b64 exec, s[14:15]
  buffer_store_dwordx4 v[244:247], v238, s[44:47], s84 offen offset:512 sc1
  s_mov_b64 exec, -1
  s_waitcnt lgkmcnt(6)
  v_mfma_f32_16x16x32_bf16 v[168:171], v[192:195], v[172:175], 0
  s_waitcnt lgkmcnt(4)
  v_mfma_f32_16x16x32_bf16 v[168:171], v[196:199], v[176:179], v[168:171]
  s_waitcnt lgkmcnt(2)
  v_mfma_f32_16x16x32_bf16 v[168:171], v[200:203], v[224:227], v[168:171]
  s_waitcnt lgkmcnt(0)
  v_mfma_f32_16x16x32_bf16 v[168:171], v[204:207], v[228:231], v[168:171]
  v_cvt_pk_bf16_f32 v248, v164, v164
  v_perm_b32 v248, v165, v248, s90
  v_cvt_pk_bf16_f32 v249, v166, v166
  v_perm_b32 v249, v167, v249, s90
  s_nop 3
  v_cvt_pk_bf16_f32 v250, v168, v168
  v_perm_b32 v250, v169, v250, s90
  s_mov_b64 exec, s[14:15]
  buffer_store_dwordx4 v[248:251], v238, s[44:47], s84 offen offset:1024 sc1
  s_mov_b64 exec, -1
  s_mov_b64 exec, -1
  s_branch L_Bq
L_Bk2:
  ds_read_b64_tr_b16 v[172:173], v0 offset:0
  ds_read_b64_tr_b16 v[174:175], v0 offset:640
  ds_read_b64_tr_b16 v[176:177], v0 offset:20480
  ds_read_b64_tr_b16 v[178:179], v0 offset:21120
  ds_read_b64_tr_b16 v[224:225], v0 offset:40960
  ds_read_b64_tr_b16 v[226:227], v0 offset:41600
  ds_read_b64_tr_b16 v[228:229], v0 offset:61440
  ds_read_b64_tr_b16 v[230:231], v0 offset:62080
  ds_read_b64_tr_b16 v[192:193], v237 offset:0
  ds_read_b64_tr_b16 v[194:195], v237 offset:2304
  ds_read_b64_tr_b16 v[196:197], v237 offset:20480
  ds_read_b64_tr_b16 v[198:199], v237 offset:22784
  ds_read_b64_tr_b16 v[200:201], v237 offset:40960
  ds_read_b64_tr_b16 v[202:203], v237 offset:43264
  ds_read_b64_tr_b16 v[204:205], v237 offset:61440
  ds_read_b64_tr_b16 v[206:207], v237 offset:63744
  v_mov_b32 v243, s60
  v_mov_b32 v247, s60
  v_mov_b32 v251, s60
  s_mov_b32 s90, 0x07060100
  s_mov_b32 s14, 0x00cc00cc
  s_mov_b32 s15, 0xcc00cc00
  s_waitcnt lgkmcnt(6)
  v_mfma_f32_16x16x32_bf16 v[152:155], v[192:195], v[172:175], 0
  ds_read_b64_tr_b16 v[208:209], v237 offset:8
  ds_read_b64_tr_b16 v[210:211], v237 offset:2312
  s_waitcnt lgkmcnt(6)
  v_mfma_f32_16x16x32_bf16 v[152:155], v[196:199], v[176:179], v[152:155]
  ds_read_b64_tr_b16 v[212:213], v237 offset:20488
  ds_read_b64_tr_b16 v[214:215], v237 offset:22792
  s_waitcnt lgkmcnt(6)
  v_mfma_f32_16x16x32_bf16 v[152:155], v[200:203], v[224:227], v[152:155]
  ds_read_b64_tr_b16 v[216:217], v237 offset:40968
  ds_read_b64_tr_b16 v[218:219], v237 offset:43272
  s_waitcnt lgkmcnt(6)
  v_mfma_f32_16x16x32_bf16 v[152:155], v[204:207], v[228:231], v[152:155]
  ds_read_b64_tr_b16 v[220:221], v237 offset:61448
  ds_read_b64_tr_b16 v[222:223], v237 offset:63752
  s_waitcnt lgkmcnt(6)
  v_mfma_f32_16x16x32_bf16 v[156:159], v[208:211], v[172:175], 0
  ds_read_b64_tr_b16 v[192:193], v237 offset:16
  ds_read_b64_tr_b16 v[194:195], v237 offset:2320
  s_waitcnt lgkmcnt(6)
  v_mfma_f32_16x16x32_bf16 v[156:159], v[212:215], v[176:179], v[156:159]
  ds_read_b64_tr_b16 v[196:197], v237 offset:20496
  ds_read_b64_tr_b16 v[198:199], v237 offset:22800
  s_waitcnt lgkmcnt(6)
  v_mfma_f32_16x16x32_bf16 v[156:159], v[216:219], v[224:227], v[156:159]
  ds_read_b64_tr_b16 v[200:201], v237 offset:40976
  ds_read_b64_tr_b16 v[202:203], v237 offset:43280
  s_waitcnt lgkmcnt(6)
  v_mfma_f32_16x16x32_bf16 v[156:159], v[220:223], v[228:231], v[156:159]
  ds_read_b64_tr_b16 v[204:205], v237 offset:61456
  ds_read_b64_tr_b16 v[206:207], v237 offset:63760
  s_waitcnt lgkmcnt(6)
  v_mfma_f32_16x16x32_bf16 v[160:163], v[192:195], v[172:175], 0
  ds_read_b64_tr_b16 v[208:209], v237 offset:24
  ds_read_b64_tr_b16 v[210:211], v237 offset:2328
  s_waitcnt lgkmcnt(6)
  v_mfma_f32_16x16x32_bf16 v[160:163], v[196:199], v[176:179], v[160:163]
  ds_read_b64_tr_b16 v[212:213], v237 offset:20504
  ds_read_b64_tr_b16 v[214:215], v237 offset:22808
  s_waitcnt lgkmcnt(6)
  v_mfma_f32_16x16x32_bf16 v[160:163], v[200:203], v[224:227], v[160:163]
  ds_read_b64_tr_b16 v[216:217], v237 offset:40984
  ds_read_b64_tr_b16 v[218:219], v237 offset:43288
  s_waitcnt lgkmcnt(6)
  v_mfma_f32_16x16x32_bf16 v[160:163], v[204:207], v[228:231], v[160:163]
  ds_read_b64_tr_b16 v[220:221], v237 offset:61464
  ds_read_b64_tr_b16 v[222:223], v237 offset:63768
  v_cvt_pk_bf16_f32 v240, v152, v152
  v_perm_b32 v240, v153, v240, s90
  v_cvt_pk_bf16_f32 v241, v154, v154
  v_perm_b32 v241, v155, v241, s90
  v_cvt_pk_bf16_f32 v242, v156, v156
  v_perm_b32 v242, v157, v242, s90
  s_mov_b64 exec, s[14:15]
  buffer_store_dwordx4 v[240:243], v238, s[44:47], s84 offen offset:0 sc1
  s_mov_b64 exec, -1
  s_waitcnt lgkmcnt(6)
  v_mfma_f32_16x16x32_bf16 v[164:167], v[208:211], v[172:175], 0
  s_waitcnt lgkmcnt(4)
  v_mfma_f32_16x16x32_bf16 v[164:167], v[212:215], v[176:179], v[164:167]
  s_waitcnt lgkmcnt(2)
  v_mfma_f32_16x16x32_bf16 v[164:167], v[216:219], v[224:227], v[164:167]
  s_waitcnt lgkmcnt(0)
  v_mfma_f32_16x16x32_bf16 v[164:167], v[220:223], v[228:231], v[164:167]
  v_cvt_pk_bf16_f32 v244, v158, v158
  v_perm_b32 v244, v159, v244, s90
  v_cvt_pk_bf16_f32 v245, v160, v160
  v_perm_b32 v245, v161, v245, s90
  v_cvt_pk_bf16_f32 v246, v162, v162
  v_perm_b32 v246, v163, v246, s90
  s_mov_b64 exec, s[14:15]
  buffer_store_dwordx4 v[244:247], v238, s[44:47], s84 offen offset:256 sc1
  s_mov_b64 exec, -1
  v_mfma_f32_16x16x32_bf16 v[168:171], v[172:175], v[172:175], 0
  v_mfma_f32_16x16x32_bf16 v[168:171], v[176:179], v[176:179], v[168:171]
  v_mfma_f32_16x16x32_bf16 v[168:171], v[224:227], v[224:227], v[168:171]
  v_mfma_f32_16x16x32_bf16 v[168:171], v[228:231], v[228:231], v[168:171]
  v_cvt_pk_bf16_f32 v248, v164, v164
  v_perm_b32 v248, v165, v248, s90
  v_cvt_pk_bf16_f32 v249, v166, v166
  v_perm_b32 v249, v167, v249, s90
  s_nop 3
  v_cvt_pk_bf16_f32 v250, v168, v168
  v_perm_b32 v250, v169, v250, s90
  s_mov_b64 exec, s[14:15]
  buffer_store_dwordx4 v[248:251], v238, s[44:47], s84 offen offset:512 sc1
  s_mov_b64 exec, -1
  s_mov_b64 exec, -1
L_Bq:
  ds_read_b128 v[192:195], v4 offset:12288
  ds_read_b128 v[196:199], v4 offset:13312
  ds_read_b128 v[200:203], v4 offset:14336
  ds_read_b128 v[204:207], v4 offset:15360
  ds_read_b128 v[208:211], v4 offset:32768
  ds_read_b128 v[212:215], v4 offset:33792
  s_waitcnt lgkmcnt(4)
  v_mfma_f32_16x16x32_bf16 v[152:155], v[192:195], v[8:11], 0
  ds_read_b128 v[216:219], v4 offset:34816
  v_mfma_f32_16x16x32_bf16 v[156:159], v[192:195], v[12:15], 0
  ds_read_b128 v[220:223], v4 offset:35840
  v_mfma_f32_16x16x32_bf16 v[160:163], v[196:199], v[8:11], 0
  v_mfma_f32_16x16x32_bf16 v[164:167], v[196:199], v[12:15], 0
  s_waitcnt lgkmcnt(4)
  v_mfma_f32_16x16x32_bf16 v[152:155], v[200:203], v[16:19], v[152:155]
  ds_read_b128 v[192:195], v252 offset:12288
  v_mfma_f32_16x16x32_bf16 v[156:159], v[200:203], v[20:23], v[156:159]
  ds_read_b128 v[196:199], v252 offset:13312
  v_mfma_f32_16x16x32_bf16 v[160:163], v[204:207], v[16:19], v[160:163]
  v_mfma_f32_16x16x32_bf16 v[164:167], v[204:207], v[20:23], v[164:167]
  s_waitcnt lgkmcnt(4)
  v_mfma_f32_16x16x32_bf16 v[152:155], v[208:211], v[24:27], v[152:155]
  ds_read_b128 v[200:203], v252 offset:14336
  v_mfma_f32_16x16x32_bf16 v[156:159], v[208:211], v[28:31], v[156:159]
  ds_read_b128 v[204:207], v252 offset:15360
  v_mfma_f32_16x16x32_bf16 v[160:163], v[212:215], v[24:27], v[160:163]
  v_mfma_f32_16x16x32_bf16 v[164:167], v[212:215], v[28:31], v[164:167]
  s_waitcnt lgkmcnt(4)
  v_mfma_f32_16x16x32_bf16 v[152:155], v[216:219], v[32:35], v[152:155]
  ds_read_b128 v[208:211], v252 offset:32768
  v_mfma_f32_16x16x32_bf16 v[156:159], v[216:219], v[36:39], v[156:159]
  ds_read_b128 v[212:215], v252 offset:33792
  v_mfma_f32_16x16x32_bf16 v[160:163], v[220:223], v[32:35], v[160:163]
  v_mfma_f32_16x16x32_bf16 v[164:167], v[220:223], v[36:39], v[164:167]
  s_waitcnt lgkmcnt(4)
  v_mfma_f32_16x16x32_bf16 v[152:155], v[192:195], v[40:43], v[152:155]
  ds_read_b128 v[216:219], v252 offset:34816
  v_mfma_f32_16x16x32_bf16 v[156:159], v[192:195], v[44:47], v[156:159]
  ds_read_b128 v[220:223], v252 offset:35840
  v_mfma_f32_16x16x32_bf16 v[160:163], v[196:199], v[40:43], v[160:163]
  v_mfma_f32_16x16x32_bf16 v[164:167], v[196:199], v[44:47], v[164:167]
  s_waitcnt lgkmcnt(4)
  v_mfma_f32_16x16x32_bf16 v[152:155], v[200:203], v[48:51], v[152:155]
  ds_read_b128 v[192:195], v4 offset:16384
  v_mfma_f32_16x16x32_bf16 v[156:159], v[200:203], v[52:55], v[156:159]
  ds_read_b128 v[196:199], v4 offset:17408
  v_mfma_f32_16x16x32_bf16 v[160:163], v[204:207], v[48:51], v[160:163]
  v_mfma_f32_16x16x32_bf16 v[164:167], v[204:207], v[52:55], v[164:167]
  s_waitcnt lgkmcnt(4)
  v_mfma_f32_16x16x32_bf16 v[152:155], v[208:211], v[56:59], v[152:155]
  ds_read_b128 v[200:203], v4 offset:18432
  v_mfma_f32_16x16x32_bf16 v[156:159], v[208:211], v[60:63], v[156:159]
  ds_read_b128 v[204:207], v4 offset:19456
  v_mfma_f32_16x16x32_bf16 v[160:163], v[212:215], v[56:59], v[160:163]
  v_mfma_f32_16x16x32_bf16 v[164:167], v[212:215], v[60:63], v[164:167]
  s_waitcnt lgkmcnt(4)
  v_mfma_f32_16x16x32_bf16 v[152:155], v[216:219], v[64:67], v[152:155]
  ds_read_b128 v[208:211], v4 offset:36864
  v_mfma_f32_16x16x32_bf16 v[156:159], v[216:219], v[68:71], v[156:159]
  ds_read_b128 v[212:215], v4 offset:37888
  v_mfma_f32_16x16x32_bf16 v[160:163], v[220:223], v[64:67], v[160:163]
  v_mfma_f32_16x16x32_bf16 v[164:167], v[220:223], v[68:71], v[164:167]
  s_waitcnt lgkmcnt(4)
  v_mfma_f32_16x16x32_bf16 v[152:155], v[192:195], v[72:75], v[152:155]
  ds_read_b128 v[216:219], v4 offset:38912
  v_mfma_f32_16x16x32_bf16 v[156:159], v[192:195], v[76:79], v[156:159]
  ds_read_b128 v[220:223], v4 offset:39936
  v_mfma_f32_16x16x32_bf16 v[160:163], v[196:199], v[72:75], v[160:163]
  v_mfma_f32_16x16x32_bf16 v[164:167], v[196:199], v[76:79], v[164:167]
  s_waitcnt lgkmcnt(4)
  v_mfma_f32_16x16x32_bf16 v[152:155], v[200:203], v[80:83], v[152:155]
  ds_read_b128 v[192:195], v252 offset:16384
  v_mfma_f32_16x16x32_bf16 v[156:159], v[200:203], v[84:87], v[156:159]
  ds_read_b128 v[196:199], v252 offset:17408
  v_mfma_f32_16x16x32_bf16 v[160:163], v[204:207], v[80:83], v[160:163]
  v_mfma_f32_16x16x32_bf16 v[164:167], v[204:207], v[84:87], v[164:167]
  s_waitcnt lgkmcnt(4)
  v_mfma_f32_16x16x32_bf16 v[152:155], v[208:211], v[88:91], v[152:155]
  ds_read_b128 v[200:203], v252 offset:18432
  v_mfma_f32_16x16x32_bf16 v[156:159], v[208:211], v[92:95], v[156:159]
  ds_read_b128 v[204:207], v252 offset:19456
  v_mfma_f32_16x16x32_bf16 v[160:163], v[212:215], v[88:91], v[160:163]
  v_mfma_f32_16x16x32_bf16 v[164:167], v[212:215], v[92:95], v[164:167]
  s_waitcnt lgkmcnt(4)
  v_mfma_f32_16x16x32_bf16 v[152:155], v[216:219], v[96:99], v[152:155]
  ds_read_b128 v[208:211], v252 offset:36864
  v_mfma_f32_16x16x32_bf16 v[156:159], v[216:219], v[100:103], v[156:159]
  ds_read_b128 v[212:215], v252 offset:37888
  v_mfma_f32_16x16x32_bf16 v[160:163], v[220:223], v[96:99], v[160:163]
  v_mfma_f32_16x16x32_bf16 v[164:167], v[220:223], v[100:103], v[164:167]
  s_waitcnt lgkmcnt(4)
  v_mfma_f32_16x16x32_bf16 v[152:155], v[192:195], v[104:107], v[152:155]
  ds_read_b128 v[216:219], v252 offset:38912
  v_mfma_f32_16x16x32_bf16 v[156:159], v[192:195], v[108:111], v[156:159]
  ds_read_b128 v[220:223], v252 offset:39936
  v_mfma_f32_16x16x32_bf16 v[160:163], v[196:199], v[104:107], v[160:163]
  v_mfma_f32_16x16x32_bf16 v[164:167], v[196:199], v[108:111], v[164:167]
  s_waitcnt lgkmcnt(4)
  v_mfma_f32_16x16x32_bf16 v[152:155], v[200:203], v[112:115], v[152:155]
  ds_read_b128 v[192:195], v252 offset:8192
  v_mfma_f32_16x16x32_bf16 v[156:159], v[200:203], v[116:119], v[156:159]
  ds_read_b128 v[196:199], v252 offset:9216
  v_mfma_f32_16x16x32_bf16 v[160:163], v[204:207], v[112:115], v[160:163]
  v_mfma_f32_16x16x32_bf16 v[164:167], v[204:207], v[116:119], v[164:167]
  s_waitcnt lgkmcnt(4)
  v_mfma_f32_16x16x32_bf16 v[152:155], v[208:211], v[120:123], v[152:155]
  ds_read_b128 v[200:203], v252 offset:10240
  v_mfma_f32_16x16x32_bf16 v[156:159], v[208:211], v[124:127], v[156:159]
  ds_read_b128 v[204:207], v252 offset:11264
  v_mfma_f32_16x16x32_bf16 v[160:163], v[212:215], v[120:123], v[160:163]
  v_mfma_f32_16x16x32_bf16 v[164:167], v[212:215], v[124:127], v[164:167]
  s_waitcnt lgkmcnt(4)
  v_mfma_f32_16x16x32_bf16 v[152:155], v[216:219], v[128:131], v[152:155]
  v_mfma_f32_16x16x32_bf16 v[156:159], v[216:219], v[132:135], v[156:159]
  v_mfma_f32_16x16x32_bf16 v[160:163], v[220:223], v[128:131], v[160:163]
  v_mfma_f32_16x16x32_bf16 v[164:167], v[220:223], v[132:135], v[164:167]
  s_waitcnt lgkmcnt(2)
  v_mfma_f32_16x16x32_bf16 v[152:155], v[192:195], v[136:139], v[152:155]
  v_mfma_f32_16x16x32_bf16 v[156:159], v[192:195], v[140:143], v[156:159]
  v_mfma_f32_16x16x32_bf16 v[160:163], v[196:199], v[136:139], v[160:163]
  v_mfma_f32_16x16x32_bf16 v[164:167], v[196:199], v[140:143], v[164:167]
  s_waitcnt lgkmcnt(0)
  v_mfma_f32_16x16x32_bf16 v[152:155], v[200:203], v[144:147], v[152:155]
  v_mfma_f32_16x16x32_bf16 v[156:159], v[200:203], v[148:151], v[156:159]
  v_mfma_f32_16x16x32_bf16 v[160:163], v[204:207], v[144:147], v[160:163]
  v_mfma_f32_16x16x32_bf16 v[164:167], v[204:207], v[148:151], v[164:167]
  s_nop 4
  v_max3_f32 v228, v152, v153, v154
  v_max3_f32 v229, -v152, -v153, -v154
  v_max3_f32 v230, v156, v157, v158
  v_max3_f32 v231, -v156, -v157, -v158
  v_max3_f32 v228, v228, v155, v160
  v_max3_f32 v229, v229, -v155, -v160
  v_max3_f32 v230, v230, v159, v164
  v_max3_f32 v231, v231, -v159, -v164
  v_max3_f32 v228, v228, v161, v162
  v_max3_f32 v229, v229, -v161, -v162
  v_max3_f32 v230, v230, v165, v166
  v_max3_f32 v231, v231, -v165, -v166
  v_max3_f32 v228, v228, v163, v186
  v_max3_f32 v229, v229, -v163, -v186
  v_max3_f32 v230, v230, v167, v190
  v_max3_f32 v231, v231, -v167, -v190
  v_permlane16_swap_b32 v228, v229
  s_nop 0
  v_permlane16_swap_b32 v230, v231
  v_max_f32 v228, v228, v229
  v_max_f32 v230, v230, v231
  v_mul_f32 v229, v228, v235
  v_mul_f32 v231, v230, v235
  v_mul_f32 v228, v228, v235
  v_mul_f32 v230, v230, v235
  s_nop 0
  v_permlane16_swap_b32 v228, v229
  v_permlane16_swap_b32 v230, v231
  v_pk_fma_f32 v[192:193], v[152:153], v[234:235], v[228:229] op_sel:[0,0,0] op_sel_hi:[0,1,1]
  v_pk_fma_f32 v[210:211], v[156:157], v[234:235], v[230:231] op_sel:[0,0,0] op_sel_hi:[0,1,1]
  v_pk_fma_f32 v[194:195], v[152:153], v[234:235], v[228:229] op_sel:[1,0,0] op_sel_hi:[1,1,1]
  v_pk_fma_f32 v[212:213], v[156:157], v[234:235], v[230:231] op_sel:[1,0,0] op_sel_hi:[1,1,1]
  v_pk_fma_f32 v[196:197], v[154:155], v[234:235], v[228:229] op_sel:[0,0,0] op_sel_hi:[0,1,1]
  v_pk_fma_f32 v[214:215], v[158:159], v[234:235], v[230:231] op_sel:[0,0,0] op_sel_hi:[0,1,1]
  v_pk_fma_f32 v[198:199], v[154:155], v[234:235], v[228:229] op_sel:[1,0,0] op_sel_hi:[1,1,1]
  v_pk_fma_f32 v[216:217], v[158:159], v[234:235], v[230:231] op_sel:[1,0,0] op_sel_hi:[1,1,1]
  v_pk_fma_f32 v[200:201], v[160:161], v[234:235], v[228:229] op_sel:[0,0,0] op_sel_hi:[0,1,1]
  v_pk_fma_f32 v[218:219], v[164:165], v[234:235], v[230:231] op_sel:[0,0,0] op_sel_hi:[0,1,1]
  v_pk_fma_f32 v[202:203], v[160:161], v[234:235], v[228:229] op_sel:[1,0,0] op_sel_hi:[1,1,1]
  v_pk_fma_f32 v[220:221], v[164:165], v[234:235], v[230:231] op_sel:[1,0,0] op_sel_hi:[1,1,1]
  v_pk_fma_f32 v[204:205], v[162:163], v[234:235], v[228:229] op_sel:[0,0,0] op_sel_hi:[0,1,1]
  v_pk_fma_f32 v[222:223], v[166:167], v[234:235], v[230:231] op_sel:[0,0,0] op_sel_hi:[0,1,1]
  v_pk_fma_f32 v[206:207], v[162:163], v[234:235], v[228:229] op_sel:[1,0,0] op_sel_hi:[1,1,1]
  v_pk_fma_f32 v[224:225], v[166:167], v[234:235], v[230:231] op_sel:[1,0,0] op_sel_hi:[1,1,1]
  v_pk_fma_f32 v[208:209], v[186:187], v[234:235], v[228:229] op_sel:[0,0,0] op_sel_hi:[0,1,1]
  v_pk_fma_f32 v[226:227], v[190:191], v[234:235], v[230:231] op_sel:[0,0,0] op_sel_hi:[0,1,1]
  v_exp_f32 v192, v192
  v_exp_f32 v193, v193
  s_mov_b32 s70, s85
  buffer_load_dwordx4 v[8:11], v239, s[44:47], s70 offen sc1
  v_exp_f32 v210, v210
  v_exp_f32 v211, v211
  v_exp_f32 v194, v194
  v_exp_f32 v195, v195
  s_add_u32 s70, s70, 4096
  buffer_load_dwordx4 v[12:15], v239, s[44:47], s70 offen sc1
  v_exp_f32 v212, v212
  v_exp_f32 v213, v213
  v_exp_f32 v196, v196
  v_exp_f32 v197, v197
  s_add_u32 s70, s70, 4096
  buffer_load_dwordx4 v[16:19], v239, s[44:47], s70 offen sc1
  v_exp_f32 v214, v214
  v_exp_f32 v215, v215
  v_pk_add_f32 v[228:229], v[192:193], v[194:195]
  v_pk_add_f32 v[230:231], v[210:211], v[212:213]
  v_exp_f32 v198, v198
  v_exp_f32 v199, v199
  s_add_u32 s70, s70, 4096
  buffer_load_dwordx4 v[20:23], v239, s[44:47], s70 offen sc1
  v_exp_f32 v216, v216
  v_exp_f32 v217, v217
  v_pk_add_f32 v[228:229], v[228:229], v[196:197]
  v_pk_add_f32 v[230:231], v[230:231], v[214:215]
  v_exp_f32 v200, v200
  v_exp_f32 v201, v201
  s_add_u32 s70, s70, 4096
  buffer_load_dwordx4 v[24:27], v239, s[44:47], s70 offen sc1
  v_exp_f32 v218, v218
  v_exp_f32 v219, v219
  v_pk_add_f32 v[228:229], v[228:229], v[198:199]
  v_pk_add_f32 v[230:231], v[230:231], v[216:217]
  v_exp_f32 v202, v202
  v_exp_f32 v203, v203
  s_add_u32 s70, s70, 4096
  buffer_load_dwordx4 v[28:31], v239, s[44:47], s70 offen sc1
  v_exp_f32 v220, v220
  v_exp_f32 v221, v221
  v_pk_add_f32 v[228:229], v[228:229], v[200:201]
  v_pk_add_f32 v[230:231], v[230:231], v[218:219]
  v_exp_f32 v204, v204
  v_exp_f32 v205, v205
  s_add_u32 s70, s70, 4096
  buffer_load_dwordx4 v[32:35], v239, s[44:47], s70 offen sc1
  v_exp_f32 v222, v222
  v_exp_f32 v223, v223
  v_pk_add_f32 v[228:229], v[228:229], v[202:203]
  v_pk_add_f32 v[230:231], v[230:231], v[220:221]
  v_exp_f32 v206, v206
  v_exp_f32 v207, v207
  s_add_u32 s70, s70, 4096
  buffer_load_dwordx4 v[36:39], v239, s[44:47], s70 offen sc1
  v_exp_f32 v224, v224
  v_exp_f32 v225, v225
  v_pk_add_f32 v[228:229], v[228:229], v[204:205]
  v_pk_add_f32 v[230:231], v[230:231], v[222:223]
  v_exp_f32 v208, v208
  v_exp_f32 v209, v209
  s_add_u32 s70, s70, 4096
  buffer_load_dwordx4 v[40:43], v239, s[44:47], s70 offen sc1
  v_exp_f32 v226, v226
  v_exp_f32 v227, v227
  v_pk_add_f32 v[228:229], v[228:229], v[206:207]
  v_pk_add_f32 v[230:231], v[230:231], v[224:225]
  v_pk_add_f32 v[228:229], v[228:229], v[208:209]
  v_pk_add_f32 v[230:231], v[230:231], v[226:227]
  s_nop 0
  v_permlane16_swap_b32 v228, v229
  v_permlane16_swap_b32 v230, v231
  v_add_f32 v228, v228, v229
  v_add_f32 v230, v230, v231
  v_rcp_f32 v229, v228
  v_rcp_f32 v231, v230
  v_rcp_f32 v228, v228
  v_rcp_f32 v230, v230
  s_nop 1
  v_permlane16_swap_b32 v228, v229
  v_permlane16_swap_b32 v230, v231
  v_pk_mul_f32 v[192:193], v[192:193], v[228:229]
  v_pk_mul_f32 v[210:211], v[210:211], v[230:231]
  s_add_u32 s70, s70, 4096
  buffer_load_dwordx4 v[44:47], v239, s[44:47], s70 offen sc1
  v_pk_mul_f32 v[194:195], v[194:195], v[228:229]
  v_pk_mul_f32 v[212:213], v[212:213], v[230:231]
  s_add_u32 s70, s70, 4096
  buffer_load_dwordx4 v[48:51], v239, s[44:47], s70 offen sc1
  v_pk_mul_f32 v[196:197], v[196:197], v[228:229]
  v_pk_mul_f32 v[214:215], v[214:215], v[230:231]
  s_add_u32 s70, s70, 4096
  buffer_load_dwordx4 v[52:55], v239, s[44:47], s70 offen sc1
  v_pk_mul_f32 v[198:199], v[198:199], v[228:229]
  v_pk_mul_f32 v[216:217], v[216:217], v[230:231]
  s_add_u32 s70, s70, 4096
  buffer_load_dwordx4 v[56:59], v239, s[44:47], s70 offen sc1
  v_pk_mul_f32 v[200:201], v[200:201], v[228:229]
  v_pk_mul_f32 v[218:219], v[218:219], v[230:231]
  s_add_u32 s70, s70, 4096
  buffer_load_dwordx4 v[60:63], v239, s[44:47], s70 offen sc1
  v_pk_mul_f32 v[202:203], v[202:203], v[228:229]
  v_pk_mul_f32 v[220:221], v[220:221], v[230:231]
  s_add_u32 s70, s70, 4096
  buffer_load_dwordx4 v[64:67], v239, s[44:47], s70 offen sc1
  v_pk_mul_f32 v[204:205], v[204:205], v[228:229]
  v_pk_mul_f32 v[222:223], v[222:223], v[230:231]
  s_add_u32 s70, s70, 4096
  buffer_load_dwordx4 v[68:71], v239, s[44:47], s70 offen sc1
  v_pk_mul_f32 v[206:207], v[206:207], v[228:229]
  v_pk_mul_f32 v[224:225], v[224:225], v[230:231]
  v_pk_mul_f32 v[208:209], v[208:209], v[228:229]
  v_pk_mul_f32 v[226:227], v[226:227], v[230:231]
  v_cvt_pk_bf16_f32 v72, v192, v193
  v_cvt_pk_bf16_f32 v73, v194, v195
  v_cvt_pk_bf16_f32 v74, v196, v197
  v_cvt_pk_bf16_f32 v76, v198, v199
  v_cvt_pk_bf16_f32 v77, v200, v201
  v_cvt_pk_bf16_f32 v78, v202, v203
  v_cvt_pk_bf16_f32 v80, v204, v205
  v_cvt_pk_bf16_f32 v81, v206, v207
  v_cvt_pk_bf16_f32 v82, v208, v209
  v_mov_b32 v75, 0
  v_mov_b32 v79, 0
  v_mov_b32 v83, 0
  v_cvt_pk_bf16_f32 v84, v210, v211
  v_cvt_pk_bf16_f32 v85, v212, v213
  v_cvt_pk_bf16_f32 v86, v214, v215
  v_cvt_pk_bf16_f32 v88, v216, v217
  v_cvt_pk_bf16_f32 v89, v218, v219
  v_cvt_pk_bf16_f32 v90, v220, v221
  v_cvt_pk_bf16_f32 v92, v222, v223
  v_cvt_pk_bf16_f32 v93, v224, v225
  v_cvt_pk_bf16_f32 v94, v226, v227
  v_mov_b32 v87, 0
  v_mov_b32 v91, 0
  v_mov_b32 v95, 0
  v_mov_b32 v139, s60
  v_mov_b32 v143, s60
  v_mov_b32 v147, s60
  v_mov_b32 v115, 0
  v_mov_b32 v116, 0
  v_mov_b32 v117, 0
  v_mov_b32 v118, 0
  v_mov_b32 v119, 0
  v_xor_b32 v6, 512, v233
  ds_write_b128 v6, v[116:119]
  s_movk_i32 s65, 3000
  s_waitcnt lgkmcnt(0)
Lr_5:
  s_waitcnt vmcnt(15)
  v_xor_b32 v5, s60, v11
  v_lshlrev_b32 v98, 16, v8
  v_lshlrev_b32 v99, 16, v9
  v_lshlrev_b32 v11, 16, v10
  s_waitcnt vmcnt(14)
  v_bitop3_b32 v5, v5, v15, s60 bitop3:0xf6
  v_lshlrev_b32 v106, 16, v12
  v_lshlrev_b32 v107, 16, v13
  v_lshlrev_b32 v15, 16, v14
  v_pk_add_f32 v[96:97], v[8:9], v[12:13]
  v_pk_add_f32 v[100:101], v[10:11], v[14:15]
  v_pk_add_f32 v[98:99], v[98:99], v[106:107]
  s_waitcnt vmcnt(13)
  v_bitop3_b32 v5, v5, v19, s60 bitop3:0xf6
  v_lshlrev_b32 v104, 16, v16
  v_lshlrev_b32 v105, 16, v17
  v_lshlrev_b32 v19, 16, v18
  v_pk_add_f32 v[96:97], v[96:97], v[16:17]
  v_pk_add_f32 v[100:101], v[100:101], v[18:19]
  v_pk_add_f32 v[98:99], v[98:99], v[104:105]
  s_waitcnt vmcnt(12)
  v_bitop3_b32 v5, v5, v23, s60 bitop3:0xf6
  v_lshlrev_b32 v106, 16, v20
  v_lshlrev_b32 v107, 16, v21
  v_lshlrev_b32 v23, 16, v22
  v_pk_add_f32 v[96:97], v[96:97], v[20:21]
  v_pk_add_f32 v[100:101], v[100:101], v[22:23]
  v_pk_add_f32 v[98:99], v[98:99], v[106:107]
  s_waitcnt vmcnt(11)
  v_bitop3_b32 v5, v5, v27, s60 bitop3:0xf6
  v_lshlrev_b32 v104, 16, v24
  v_lshlrev_b32 v105, 16, v25
  v_lshlrev_b32 v27, 16, v26
  v_pk_add_f32 v[96:97], v[96:97], v[24:25]
  v_pk_add_f32 v[100:101], v[100:101], v[26:27]
  v_pk_add_f32 v[98:99], v[98:99], v[104:105]
  s_waitcnt vmcnt(10)
  v_bitop3_b32 v5, v5, v31, s60 bitop3:0xf6
  v_lshlrev_b32 v106, 16, v28
  v_lshlrev_b32 v107, 16, v29
  v_lshlrev_b32 v31, 16, v30
  v_pk_add_f32 v[96:97], v[96:97], v[28:29]
  v_pk_add_f32 v[100:101], v[100:101], v[30:31]
  v_pk_add_f32 v[98:99], v[98:99], v[106:107]
  s_waitcnt vmcnt(9)
  v_bitop3_b32 v5, v5, v35, s60 bitop3:0xf6
  v_lshlrev_b32 v104, 16, v32
  v_lshlrev_b32 v105, 16, v33
  v_lshlrev_b32 v35, 16, v34
  v_pk_add_f32 v[96:97], v[96:97], v[32:33]
  v_pk_add_f32 v[100:101], v[100:101], v[34:35]
  v_pk_add_f32 v[98:99], v[98:99], v[104:105]
  s_waitcnt vmcnt(8)
  v_bitop3_b32 v5, v5, v39, s60 bitop3:0xf6
  v_lshlrev_b32 v106, 16, v36
  v_lshlrev_b32 v107, 16, v37
  v_lshlrev_b32 v39, 16, v38
  v_pk_add_f32 v[96:97], v[96:97], v[36:37]
  v_pk_add_f32 v[100:101], v[100:101], v[38:39]
  v_pk_add_f32 v[98:99], v[98:99], v[106:107]
  s_waitcnt vmcnt(7)
  v_bitop3_b32 v5, v5, v43, s60 bitop3:0xf6
  v_lshlrev_b32 v104, 16, v40
  v_lshlrev_b32 v105, 16, v41
  v_lshlrev_b32 v43, 16, v42
  v_pk_add_f32 v[96:97], v[96:97], v[40:41]
  v_pk_add_f32 v[100:101], v[100:101], v[42:43]
  v_pk_add_f32 v[98:99], v[98:99], v[104:105]
  s_waitcnt vmcnt(6)
  v_bitop3_b32 v5, v5, v47, s60 bitop3:0xf6
  v_lshlrev_b32 v106, 16, v44
  v_lshlrev_b32 v107, 16, v45
  v_lshlrev_b32 v47, 16, v46
  v_pk_add_f32 v[96:97], v[96:97], v[44:45]
  v_pk_add_f32 v[100:101], v[100:101], v[46:47]
  v_pk_add_f32 v[98:99], v[98:99], v[106:107]
  s_waitcnt vmcnt(5)
  v_bitop3_b32 v5, v5, v51, s60 bitop3:0xf6
  v_lshlrev_b32 v104, 16, v48
  v_lshlrev_b32 v105, 16, v49
  v_lshlrev_b32 v51, 16, v50
  v_pk_add_f32 v[96:97], v[96:97], v[48:49]
  v_pk_add_f32 v[100:101], v[100:101], v[50:51]
  v_pk_add_f32 v[98:99], v[98:99], v[104:105]
  s_waitcnt vmcnt(4)
  v_bitop3_b32 v5, v5, v55, s60 bitop3:0xf6
  v_lshlrev_b32 v106, 16, v52
  v_lshlrev_b32 v107, 16, v53
  v_lshlrev_b32 v55, 16, v54
  v_pk_add_f32 v[96:97], v[96:97], v[52:53]
  v_pk_add_f32 v[100:101], v[100:101], v[54:55]
  v_pk_add_f32 v[98:99], v[98:99], v[106:107]
  s_waitcnt vmcnt(3)
  v_bitop3_b32 v5, v5, v59, s60 bitop3:0xf6
  v_lshlrev_b32 v104, 16, v56
  v_lshlrev_b32 v105, 16, v57
  v_lshlrev_b32 v59, 16, v58
  v_pk_add_f32 v[96:97], v[96:97], v[56:57]
  v_pk_add_f32 v[100:101], v[100:101], v[58:59]
  v_pk_add_f32 v[98:99], v[98:99], v[104:105]
  s_waitcnt vmcnt(2)
  v_bitop3_b32 v5, v5, v63, s60 bitop3:0xf6
  v_lshlrev_b32 v106, 16, v60
  v_lshlrev_b32 v107, 16, v61
  v_lshlrev_b32 v63, 16, v62
  v_pk_add_f32 v[96:97], v[96:97], v[60:61]
  v_pk_add_f32 v[100:101], v[100:101], v[62:63]
  v_pk_add_f32 v[98:99], v[98:99], v[106:107]
  s_waitcnt vmcnt(1)
  v_bitop3_b32 v5, v5, v67, s60 bitop3:0xf6
  v_lshlrev_b32 v104, 16, v64
  v_lshlrev_b32 v105, 16, v65
  v_lshlrev_b32 v67, 16, v66
  v_pk_add_f32 v[96:97], v[96:97], v[64:65]
  v_pk_add_f32 v[100:101], v[100:101], v[66:67]
  v_pk_add_f32 v[98:99], v[98:99], v[104:105]
  s_waitcnt vmcnt(0)
  v_bitop3_b32 v5, v5, v71, s60 bitop3:0xf6
  v_lshlrev_b32 v106, 16, v68
  v_lshlrev_b32 v107, 16, v69
  v_lshlrev_b32 v71, 16, v70
  v_pk_add_f32 v[96:97], v[96:97], v[68:69]
  v_pk_add_f32 v[100:101], v[100:101], v[70:71]
  v_pk_add_f32 v[98:99], v[98:99], v[106:107]
  v_cmp_ne_u32 vcc, 0, v5
  s_sub_u32 s65, s65, 1
  s_cbranch_scc1 Lok_6
  s_cbranch_vccz Lok_6
  s_mov_b32 s70, s85
  buffer_load_dwordx4 v[8:11], v239, s[44:47], s70 offen sc1
  s_add_u32 s70, s70, 4096
  buffer_load_dwordx4 v[12:15], v239, s[44:47], s70 offen sc1
  s_add_u32 s70, s70, 4096
  buffer_load_dwordx4 v[16:19], v239, s[44:47], s70 offen sc1
  s_add_u32 s70, s70, 4096
  buffer_load_dwordx4 v[20:23], v239, s[44:47], s70 offen sc1
  s_add_u32 s70, s70, 4096
  buffer_load_dwordx4 v[24:27], v239, s[44:47], s70 offen sc1
  s_add_u32 s70, s70, 4096
  buffer_load_dwordx4 v[28:31], v239, s[44:47], s70 offen sc1
  s_add_u32 s70, s70, 4096
  buffer_load_dwordx4 v[32:35], v239, s[44:47], s70 offen sc1
  s_add_u32 s70, s70, 4096
  buffer_load_dwordx4 v[36:39], v239, s[44:47], s70 offen sc1
  s_add_u32 s70, s70, 4096
  buffer_load_dwordx4 v[40:43], v239, s[44:47], s70 offen sc1
  s_add_u32 s70, s70, 4096
  buffer_load_dwordx4 v[44:47], v239, s[44:47], s70 offen sc1
  s_add_u32 s70, s70, 4096
  buffer_load_dwordx4 v[48:51], v239, s[44:47], s70 offen sc1
  s_add_u32 s70, s70, 4096
  buffer_load_dwordx4 v[52:55], v239, s[44:47], s70 offen sc1
  s_add_u32 s70, s70, 4096
  buffer_load_dwordx4 v[56:59], v239, s[44:47], s70 offen sc1
  s_add_u32 s70, s70, 4096
  buffer_load_dwordx4 v[60:63], v239, s[44:47], s70 offen sc1
  s_add_u32 s70, s70, 4096
  buffer_load_dwordx4 v[64:67], v239, s[44:47], s70 offen sc1
  s_add_u32 s70, s70, 4096
  buffer_load_dwordx4 v[68:71], v239, s[44:47], s70 offen sc1
  s_branch Lr_5
Lok_6:
  v_cvt_pk_bf16_f32 v112, v98, v96
  v_cvt_pk_bf16_f32 v113, v99, v97
  v_cvt_pk_bf16_f32 v114, v101, v100
  ds_write_b128 v233, v[112:115]
  s_waitcnt lgkmcnt(0)
  s_barrier
  ds_read_b128 v[32:35], v252 offset:28672
  ds_read_b128 v[8:11], v4 offset:8192
  ds_read_b128 v[20:23], v4 offset:28672
  ds_read_b128 v[36:39], v252 offset:29696
  ds_read_b128 v[12:15], v4 offset:9216
  ds_read_b128 v[24:27], v4 offset:29696
  ds_read_b128 v[40:43], v252 offset:30720
  ds_read_b128 v[16:19], v4 offset:10240
  ds_read_b128 v[28:31], v4 offset:30720
  s_waitcnt lgkmcnt(8)
  v_mfma_f32_16x16x32_bf16 v[60:63], v[32:35], v[72:75], 0
  v_mfma_f32_16x16x32_bf16 v[64:67], v[32:35], v[84:87], 0
  s_waitcnt lgkmcnt(7)
  v_mfma_f32_16x16x32_bf16 v[44:47], v[8:11], v[72:75], 0
  v_mfma_f32_16x16x32_bf16 v[48:51], v[8:11], v[84:87], 0
  s_waitcnt lgkmcnt(6)
  v_mfma_f32_16x16x32_bf16 v[52:55], v[20:23], v[72:75], 0
  v_mfma_f32_16x16x32_bf16 v[56:59], v[20:23], v[84:87], 0
  s_waitcnt lgkmcnt(5)
  v_mfma_f32_16x16x32_bf16 v[60:63], v[36:39], v[76:79], v[60:63]
  v_mfma_f32_16x16x32_bf16 v[64:67], v[36:39], v[88:91], v[64:67]
  s_waitcnt lgkmcnt(4)
  v_mfma_f32_16x16x32_bf16 v[44:47], v[12:15], v[76:79], v[44:47]
  v_mfma_f32_16x16x32_bf16 v[48:51], v[12:15], v[88:91], v[48:51]
  s_waitcnt lgkmcnt(3)
  v_mfma_f32_16x16x32_bf16 v[52:55], v[24:27], v[76:79], v[52:55]
  v_mfma_f32_16x16x32_bf16 v[56:59], v[24:27], v[88:91], v[56:59]
  s_waitcnt lgkmcnt(2)
  v_mfma_f32_16x16x32_bf16 v[60:63], v[40:43], v[80:83], v[60:63]
  v_mfma_f32_16x16x32_bf16 v[64:67], v[40:43], v[92:95], v[64:67]
  s_waitcnt lgkmcnt(1)
  v_mfma_f32_16x16x32_bf16 v[44:47], v[16:19], v[80:83], v[44:47]
  v_mfma_f32_16x16x32_bf16 v[48:51], v[16:19], v[92:95], v[48:51]
  s_waitcnt lgkmcnt(0)
  v_mfma_f32_16x16x32_bf16 v[52:55], v[28:31], v[80:83], v[52:55]
  v_mfma_f32_16x16x32_bf16 v[56:59], v[28:31], v[92:95], v[56:59]
  s_nop 0
  v_add_f32 v63, 0x358637bd, v63
  v_rcp_f32 v63, v63
  v_add_f32 v67, 0x358637bd, v67
  v_rcp_f32 v67, v67
  s_nop 0
  v_pk_mul_f32 v[44:45], v[62:63], v[44:45] op_sel:[1,0] op_sel_hi:[1,1]
  v_pk_mul_f32 v[46:47], v[62:63], v[46:47] op_sel:[1,0] op_sel_hi:[1,1]
  v_pk_mul_f32 v[52:53], v[62:63], v[52:53] op_sel:[1,0] op_sel_hi:[1,1]
  v_pk_mul_f32 v[54:55], v[62:63], v[54:55] op_sel:[1,0] op_sel_hi:[1,1]
  v_mul_f32 v62, v62, v63
  v_cvt_pk_bf16_f32 v136, v44, v45
  v_cvt_pk_bf16_f32 v137, v46, v47
  v_cvt_pk_bf16_f32 v138, v52, v53
  v_cvt_pk_bf16_f32 v144, v54, v55
  buffer_store_dwordx4 v[136:139], v4, s[44:47], s86 offen offset:0 sc1
  v_pk_mul_f32 v[48:49], v[66:67], v[48:49] op_sel:[1,0] op_sel_hi:[1,1]
  v_pk_mul_f32 v[50:51], v[66:67], v[50:51] op_sel:[1,0] op_sel_hi:[1,1]
  v_pk_mul_f32 v[56:57], v[66:67], v[56:57] op_sel:[1,0] op_sel_hi:[1,1]
  v_pk_mul_f32 v[58:59], v[66:67], v[58:59] op_sel:[1,0] op_sel_hi:[1,1]
  v_mul_f32 v66, v66, v67
  v_cvt_pk_bf16_f32 v140, v48, v49
  v_cvt_pk_bf16_f32 v141, v50, v51
  v_cvt_pk_bf16_f32 v142, v56, v57
  v_cvt_pk_bf16_f32 v145, v58, v59
  buffer_store_dwordx4 v[140:143], v4, s[44:47], s86 offen offset:1024 sc1
  v_cvt_pk_bf16_f32 v146, v62, v66
  buffer_store_dwordx4 v[144:147], v4, s[44:47], s86 offen offset:2048 sc1
  s_lshl_b32 s71, s2, 7
  s_add_u32 s71, s71, 12419072
  s_cmp_eq_u32 s61, 0
  s_cselect_b64 exec, 1, 0
  buffer_store_dword v139, v4, s[44:47], s71 offen sc1
  s_mov_b64 exec, -1
  s_setprio 0
  s_or_b32 s71, s2, s61
  s_cmp_lg_u32 s71, 0
  s_cbranch_scc1 L_Bne
  v_lshlrev_b32 v5, 7, v1
  v_lshlrev_b32 v8, 12, v1
  s_movk_i32 s65, 3000
  s_waitcnt vmcnt(0)
Lep_7:
  s_mov_b32 s71, 12353536
  buffer_load_dword v10, v5, s[44:47], s71 offen sc1
  s_mov_b32 s71, 7864332
  buffer_load_dword v11, v8, s[44:47], s71 offen sc1
  s_mov_b32 s71, 12361728
  buffer_load_dword v12, v5, s[44:47], s71 offen sc1
  s_mov_b32 s71, 8126476
  buffer_load_dword v13, v8, s[44:47], s71 offen sc1
  s_mov_b32 s71, 12369920
  buffer_load_dword v14, v5, s[44:47], s71 offen sc1
  s_mov_b32 s71, 8388620
  buffer_load_dword v15, v8, s[44:47], s71 offen sc1
  s_mov_b32 s71, 12378112
  buffer_load_dword v16, v5, s[44:47], s71 offen sc1
  s_mov_b32 s71, 8650764
  buffer_load_dword v17, v8, s[44:47], s71 offen sc1
  s_waitcnt vmcnt(7)
  v_xor_b32 v6, s60, v10
  s_waitcnt vmcnt(6)
  v_bitop3_b32 v6, v6, v11, s60 bitop3:0xf6
  s_waitcnt vmcnt(5)
  v_bitop3_b32 v6, v6, v12, s60 bitop3:0xf6
  s_waitcnt vmcnt(4)
  v_bitop3_b32 v6, v6, v13, s60 bitop3:0xf6
  s_waitcnt vmcnt(3)
  v_bitop3_b32 v6, v6, v14, s60 bitop3:0xf6
  s_waitcnt vmcnt(2)
  v_bitop3_b32 v6, v6, v15, s60 bitop3:0xf6
  s_waitcnt vmcnt(1)
  v_bitop3_b32 v6, v6, v16, s60 bitop3:0xf6
  s_waitcnt vmcnt(0)
  v_bitop3_b32 v6, v6, v17, s60 bitop3:0xf6
  v_cmp_ne_u32 vcc, 0, v6
  s_sub_u32 s65, s65, 1
  s_cbranch_scc1 Lepd_8
  s_cbranch_vccz Lepd_8
  s_sleep 8
  s_branch Lep_7
Lepd_8:
  v_mov_b32 v6, s60
  s_mov_b64 exec, 1
  buffer_store_dword v6, v4, s[44:47], 0 offen sc1
  s_mov_b64 exec, -1
  s_branch L_Bend
L_Bne:
  s_cmp_lg_u32 s61, 3
  s_cbranch_scc1 L_Bend
  s_mov_b64 s[56:57], s[38:39]
  s_mov_b32 s58, 4718592
  s_mov_b32 s59, 0x20000
  s_lshl_b32 s70, s62, 2
  s_lshr_b32 s71, s63, 3
  s_add_u32 s70, s70, s71
  s_and_b32 s71, s63, 7
  s_lshl_b32 s72, s71, 12
  s_add_u32 s72, s72, 12386304
  v_and_b32 v5, 31, v1
  v_lshlrev_b32 v5, 7, v5
  v_lshrrev_b32 v62, 3, v1
  v_and_b32 v6, 7, v1
  v_lshlrev_b32 v6, 4, v6
  v_lshl_add_u32 v62, v62, 12, v6
  v_add_u32 v63, 31744, v62
  v_add_u32 v64, 63488, v62
  v_add_u32 v65, 95232, v62
  s_mul_i32 s74, s71, 294912
  s_lshl_b32 s73, s70, 7
  s_add_u32 s74, s74, s73
  s_add_u32 s74, s74, 5505024
  s_mov_b32 m0, 32768
  v_bfe_u32 v66, v1, 2, 2
  v_lshlrev_b32 v66, 7, v66
  v_lshl_add_u32 v66, v3, 5, v66
  v_and_b32 v6, 3, v1
  v_lshl_add_u32 v66, v6, 3, v66
  v_mul_u32_u24 v67, 144, v1
  s_movk_i32 s75, 2160
  v_add_u32 v50, 0, v1
  v_mul_u32_u24 v50, 7282, v50
  v_lshrrev_b32 v50, 16, v50
  v_mad_u32_u24 v52, v50, s75, v4
  v_add_u32 v50, 64, v1
  v_mul_u32_u24 v50, 7282, v50
  v_lshrrev_b32 v50, 16, v50
  v_mad_u32_u24 v53, v50, s75, v4
  v_add_u32 v50, 128, v1
  v_mul_u32_u24 v50, 7282, v50
  v_lshrrev_b32 v50, 16, v50
  v_mad_u32_u24 v54, v50, s75, v4
  v_add_u32 v50, 192, v1
  v_mul_u32_u24 v50, 7282, v50
  v_lshrrev_b32 v50, 16, v50
  v_mad_u32_u24 v55, v50, s75, v4
  v_add_u32 v50, 256, v1
  v_mul_u32_u24 v50, 7282, v50
  v_lshrrev_b32 v50, 16, v50
  v_mad_u32_u24 v56, v50, s75, v4
  v_add_u32 v50, 320, v1
  v_mul_u32_u24 v50, 7282, v50
  v_lshrrev_b32 v50, 16, v50
  v_mad_u32_u24 v57, v50, s75, v4
  v_add_u32 v50, 384, v1
  v_mul_u32_u24 v50, 7282, v50
  v_lshrrev_b32 v50, 16, v50
  v_mad_u32_u24 v58, v50, s75, v4
  v_add_u32 v50, 448, v1
  v_mul_u32_u24 v50, 7282, v50
  v_lshrrev_b32 v50, 16, v50
  v_mad_u32_u24 v59, v50, s75, v4
  v_add_u32 v50, 512, v1
  v_mul_u32_u24 v50, 7282, v50
  v_lshrrev_b32 v50, 16, v50
  v_mad_u32_u24 v60, v50, s75, v4
  s_mul_i32 s76, s70, 147456
  s_mul_i32 s73, s71, 144
  s_add_u32 s76, s76, s73
  s_add_u32 s77, s76, 4096
  s_add_u32 s78, s76, 8192
  s_waitcnt vmcnt(0) lgkmcnt(0)
  s_movk_i32 s65, 3000
Lpoll_9:
  buffer_load_dword v68, v5, s[44:47], s72 offen sc1
  s_sub_u32 s65, s65, 1
  s_cbranch_scc1 Lpolld_10x
  s_waitcnt vmcnt(0)
  v_cmp_ne_u32 vcc, s60, v68
  s_nop 0
  s_cbranch_vccz Lpolld_10
  s_sleep 4
  s_branch Lpoll_9
Lpolld_10x:
  s_waitcnt vmcnt(0)
Lpolld_10:
  buffer_load_dwordx4 v62, s[44:47], s74 offen offset:0 sc1 lds
  buffer_load_dwordx4 v63, s[44:47], s74 offen offset:1024 sc1 lds
  buffer_load_dwordx4 v64, s[44:47], s74 offen offset:2048 sc1 lds
  buffer_load_dwordx4 v65, s[44:47], s74 offen offset:3072 sc1 lds
  s_add_u32 s74, s74, 131072
  s_add_u32 m0, m0, 4096
  s_nop 0
  buffer_load_dwordx4 v62, s[44:47], s74 offen offset:0 sc1 lds
  buffer_load_dwordx4 v63, s[44:47], s74 offen offset:1024 sc1 lds
  buffer_load_dwordx4 v64, s[44:47], s74 offen offset:2048 sc1 lds
  buffer_load_dwordx4 v65, s[44:47], s74 offen offset:3072 sc1 lds
  s_add_u32 s74, s74, 131072
  s_add_u32 m0, m0, 4096
  s_nop 0
  buffer_load_dwordx4 v62, s[44:47], s74 offen offset:0 sc1 lds
  s_waitcnt vmcnt(0)
  ds_read_b64_tr_b16 v[8:9], v66 offset:32768
  ds_read_b64_tr_b16 v[10:11], v66 offset:33280
  ds_read_b64_tr_b16 v[12:13], v66 offset:33792
  ds_read_b64_tr_b16 v[14:15], v66 offset:34304
  ds_read_b64_tr_b16 v[16:17], v66 offset:34816
  ds_read_b64_tr_b16 v[18:19], v66 offset:35328
  ds_read_b64_tr_b16 v[20:21], v66 offset:35840
  ds_read_b64_tr_b16 v[22:23], v66 offset:36352
  ds_read_b64_tr_b16 v[24:25], v66 offset:36864
  ds_read_b64_tr_b16 v[26:27], v66 offset:37376
  ds_read_b64_tr_b16 v[28:29], v66 offset:37888
  ds_read_b64_tr_b16 v[30:31], v66 offset:38400
  ds_read_b64_tr_b16 v[32:33], v66 offset:38912
  ds_read_b64_tr_b16 v[34:35], v66 offset:39424
  ds_read_b64_tr_b16 v[36:37], v66 offset:39936
  ds_read_b64_tr_b16 v[38:39], v66 offset:40448
  ds_read_b64_tr_b16 v[40:41], v66 offset:40960
  ds_read_b64_tr_b16 v[42:43], v66 offset:41472
  s_waitcnt lgkmcnt(15)
  ds_write_b128 v67, v[8:11] offset:41984
  s_waitcnt lgkmcnt(15)
  ds_write_b128 v67, v[12:15] offset:42000
  s_waitcnt lgkmcnt(14)
  ds_write_b128 v67, v[16:19] offset:42016
  s_waitcnt lgkmcnt(13)
  ds_write_b128 v67, v[20:23] offset:42032
  s_waitcnt lgkmcnt(12)
  ds_write_b128 v67, v[24:27] offset:42048
  s_waitcnt lgkmcnt(11)
  ds_write_b128 v67, v[28:31] offset:42064
  s_waitcnt lgkmcnt(10)
  ds_write_b128 v67, v[32:35] offset:42080
  s_waitcnt lgkmcnt(9)
  ds_write_b128 v67, v[36:39] offset:42096
  s_waitcnt lgkmcnt(8)
  ds_write_b128 v67, v[40:43] offset:42112
  ds_read_b128 v[8:11], v4 offset:41984
  ds_read_b128 v[12:15], v4 offset:43008
  ds_read_b128 v[16:19], v4 offset:44032
  ds_read_b128 v[20:23], v4 offset:45056
  ds_read_b128 v[24:27], v4 offset:46080
  ds_read_b128 v[28:31], v4 offset:47104
  ds_read_b128 v[32:35], v4 offset:48128
  ds_read_b128 v[36:39], v4 offset:49152
  ds_read_b128 v[40:43], v4 offset:50176
  s_waitcnt lgkmcnt(8)
  buffer_store_dwordx4 v[8:11], v52, s[56:59], s76 offen offset:0
  s_waitcnt lgkmcnt(7)
  buffer_store_dwordx4 v[12:15], v53, s[56:59], s76 offen offset:1024
  s_waitcnt lgkmcnt(6)
  buffer_store_dwordx4 v[16:19], v54, s[56:59], s76 offen offset:2048
  s_waitcnt lgkmcnt(5)
  buffer_store_dwordx4 v[20:23], v55, s[56:59], s76 offen offset:3072
  s_waitcnt lgkmcnt(4)
  buffer_store_dwordx4 v[24:27], v56, s[56:59], s77 offen offset:0
  s_waitcnt lgkmcnt(3)
  buffer_store_dwordx4 v[28:31], v57, s[56:59], s77 offen offset:1024
  s_waitcnt lgkmcnt(2)
  buffer_store_dwordx4 v[32:35], v58, s[56:59], s77 offen offset:2048
  s_waitcnt lgkmcnt(1)
  buffer_store_dwordx4 v[36:39], v59, s[56:59], s77 offen offset:3072
  s_waitcnt lgkmcnt(0)
  buffer_store_dwordx4 v[40:43], v60, s[56:59], s78 offen offset:0
L_Bend:
L_end:
  s_endpgm
L_A:
  s_mul_i32 s64, s61, 8448
  s_add_u32 s64, s64, 30720
  s_cmp_eq_u32 s61, 3
  s_cbranch_scc1 L_A3
  s_lshl_b32 s89, s62, 3
  s_lshr_b32 s84, s63, 2
  s_add_u32 s89, s89, s84
  s_mul_i32 s89, s89, 9
  s_and_b32 s84, s63, 3
  s_lshl_b32 s84, s84, 1
  s_add_u32 s84, s84, s61
  s_cmp_lt_u32 s61, 2
  s_cselect_b32 s84, s84, 8
  s_add_u32 s86, s89, s84
  s_lshl_b32 s84, s86, 8
  v_lshl_add_u32 v110, v1, 2, s84
  s_lshl_b32 s84, s86, 1
  v_mov_b32 v111, s84
  s_waitcnt lgkmcnt(0)
  global_load_dword v104, v110, s[18:19]
  global_load_dword v105, v110, s[20:21]
  global_load_dword v106, v110, s[22:23]
  global_load_dword v107, v110, s[24:25]
  global_load_ushort v108, v111, s[26:27]
  global_load_ushort v109, v111, s[28:29]
  s_load_dword s60, s[42:43], 0
  s_mov_b64 s[44:45], s[42:43]
  s_mov_b32 s46, 13631488
  s_mov_b32 s47, 0x20000
  s_mul_i32 s87, s61, 10240
  s_mov_b32 s72, 1069066811
  s_mov_b32 s73, 1042479491
  v_lshl_add_u32 v28, v1, 3, s64
  v_mul_u32_u24 v29, 528, v2
  v_lshl_add_u32 v29, v3, 4, v29
  v_add_u32 v29, s64, v29
  v_mov_b32 v32, 0
  v_mov_b32 v33, 0
  v_mov_b32 v34, 0
  v_mov_b32 v35, 0
  v_add_u32 v5, s87, v4
  ds_write_b128 v5, v[32:35] offset:0
  ds_write_b128 v5, v[32:35] offset:1024
  ds_write_b128 v5, v[32:35] offset:2048
  ds_write_b128 v5, v[32:35] offset:3072
  ds_write_b128 v5, v[32:35] offset:4096
  ds_write_b128 v5, v[32:35] offset:5120
  v_add_u32 v36, 2112, v28
  v_add_u32 v37, 4224, v28
  v_add_u32 v38, 6336, v28
  v_and_b32 v5, 1, v3
  v_lshlrev_b32 v5, 3, v5
  v_lshl_add_u32 v5, v2, 4, v5
  v_lshrrev_b32 v6, 1, v3
  v_lshl_add_u32 v5, v6, 8, v5
  s_add_u32 s74, s87, 512
  v_sub_u32 v64, s74, v5
  v_lshlrev_b32 v5, 4, v2
  v_lshl_add_u32 v5, v3, 8, v5
  v_sub_u32 v65, s74, v5
  v_and_b32 v5, 14, v2
  v_lshl_add_u32 v6, v3, 5, v5
  s_add_u32 s74, s87, 256
  v_sub_u32 v6, s74, v6
  v_and_b32 v7, 1, v2
  v_cmp_eq_u32 vcc, 1, v7
  v_mul_u32_u24 v7, 288, v7
  v_add_u32 v67, v6, v7
  v_mov_b32 v7, 434
  v_mov_b32 v70, 144
  v_cndmask_b32 v7, v7, v70, vcc
  v_add_u32 v66, v6, v7
  v_lshl_add_u32 v6, v3, 6, v5
  v_sub_u32 v6, s74, v6
  v_mov_b32 v7, 194
  v_cndmask_b32 v7, v7, 0, vcc
  v_add_u32 v68, v6, v7
  v_mov_b32 v69, s87
  s_waitcnt lgkmcnt(0)
  s_mul_i32 s60, s60, 1664525
  s_add_u32 s60, s60, 1013904223
  s_barrier
  s_setprio 3
  s_waitcnt vmcnt(1)
  v_lshlrev_b32 v30, 16, v108
  v_mul_f32 v30, s72, v30
  v_exp_f32 v30, v30
  v_lshlrev_b32 v112, 16, v104
  v_mul_f32 v112, s72, v112
  v_exp_f32 v112, v112
  v_lshlrev_b32 v113, 16, v105
  v_lshlrev_b32 v114, 16, v106
  v_lshlrev_b32 v115, 16, v107
  v_and_b32 v144, 0xffff0000, v104
  v_mul_f32 v144, s72, v144
  v_exp_f32 v144, v144
  v_and_b32 v145, 0xffff0000, v105
  v_and_b32 v146, 0xffff0000, v106
  v_and_b32 v147, 0xffff0000, v107
  v_cvt_pk_bf16_f32 v30, v30, v30
  v_cvt_pk_bf16_f32 v6, v112, v144
  v_lshlrev_b32 v30, 16, v30
  v_lshlrev_b32 v112, 16, v6
  v_and_b32 v144, 0xffff0000, v6
  v_add_f32 v31, v30, v30
  v_pk_mul_f32 v[112:113], v[112:113], v[30:31] op_sel:[0,0] op_sel_hi:[1,0]
  v_pk_mul_f32 v[112:113], v[112:113], s[72:73]
  v_pk_mul_f32 v[114:115], v[30:31], v[114:115] op_sel:[1,0] op_sel_hi:[1,1]
  v_pk_mul_f32 v[144:145], v[144:145], v[30:31] op_sel:[0,0] op_sel_hi:[1,0]
  v_pk_mul_f32 v[144:145], v[144:145], s[72:73]
  v_pk_mul_f32 v[146:147], v[30:31], v[146:147] op_sel:[1,0] op_sel_hi:[1,1]
  v_mul_f32 v124, 0xc1000000, v112
  v_mul_f32 v125, 0xc1000000, v113
  v_exp_f32 v124, v124
  v_fract_f32 v125, v125
  v_cos_f32 v116, v125
  v_sin_f32 v117, v125
  v_mul_f32 v156, 0xc1000000, v144
  v_mul_f32 v157, 0xc1000000, v145
  v_exp_f32 v156, v156
  v_fract_f32 v157, v157
  v_cos_f32 v148, v157
  v_sin_f32 v149, v157
  v_pk_mul_f32 v[116:117], v[116:117], v[124:125] op_sel:[0,0] op_sel_hi:[1,0]
  s_nop 1
  v_pk_mul_f32 v[148:149], v[148:149], v[156:157] op_sel:[0,0] op_sel_hi:[1,0]
  v_mul_f32 v124, 0xbf800000, v112
  v_mul_f32 v125, 0x3f800000, v113
  v_exp_f32 v124, v124
  v_fract_f32 v125, v125
  v_cos_f32 v126, v125
  v_sin_f32 v127, v125
  v_mul_f32 v156, 0xbf800000, v144
  v_mul_f32 v157, 0x3f800000, v145
  v_exp_f32 v156, v156
  v_fract_f32 v157, v157
  v_cos_f32 v158, v157
  v_sin_f32 v159, v157
  v_pk_mul_f32 v[126:127], v[126:127], v[124:125] op_sel:[0,0] op_sel_hi:[1,0]
  s_nop 1
  v_pk_mul_f32 v[158:159], v[158:159], v[156:157] op_sel:[0,0] op_sel_hi:[1,0]
  v_mul_f32 v124, 0xc3000000, v112
  v_mul_f32 v125, 0x43000000, v113
  v_exp_f32 v124, v124
  v_fract_f32 v125, v125
  v_cos_f32 v118, v125
  v_sin_f32 v119, v125
  v_mul_f32 v156, 0xc3000000, v144
  v_mul_f32 v157, 0x43000000, v145
  v_exp_f32 v156, v156
  v_fract_f32 v157, v157
  v_cos_f32 v150, v157
  v_sin_f32 v151, v157
  v_pk_mul_f32 v[118:119], v[118:119], v[124:125] op_sel:[0,0] op_sel_hi:[1,0]
  s_nop 1
  v_pk_mul_f32 v[150:151], v[150:151], v[156:157] op_sel:[0,0] op_sel_hi:[1,0]
  v_pk_mul_f32 v[128:129], v[126:127], v[126:127] op_sel:[0,0] op_sel_hi:[0,1]
  v_pk_mul_f32 v[160:161], v[158:159], v[158:159] op_sel:[0,0] op_sel_hi:[0,1]
  v_pk_fma_f32 v[128:129], v[126:127], v[126:127], v[128:129] op_sel:[1,1,0] op_sel_hi:[1,0,1] neg_lo:[0,1,0]
  v_pk_fma_f32 v[160:161], v[158:159], v[158:159], v[160:161] op_sel:[1,1,0] op_sel_hi:[1,0,1] neg_lo:[0,1,0]
  v_pk_mul_f32 v[130:131], v[128:129], v[126:127] op_sel:[0,0] op_sel_hi:[0,1]
  v_pk_mul_f32 v[162:163], v[160:161], v[158:159] op_sel:[0,0] op_sel_hi:[0,1]
  v_pk_fma_f32 v[130:131], v[128:129], v[126:127], v[130:131] op_sel:[1,1,0] op_sel_hi:[1,0,1] neg_lo:[0,1,0]
  v_pk_fma_f32 v[162:163], v[160:161], v[158:159], v[162:163] op_sel:[1,1,0] op_sel_hi:[1,0,1] neg_lo:[0,1,0]
  v_pk_mul_f32 v[132:133], v[130:131], v[126:127] op_sel:[0,0] op_sel_hi:[0,1]
  v_pk_mul_f32 v[164:165], v[162:163], v[158:159] op_sel:[0,0] op_sel_hi:[0,1]
  v_pk_fma_f32 v[132:133], v[130:131], v[126:127], v[132:133] op_sel:[1,1,0] op_sel_hi:[1,0,1] neg_lo:[0,1,0]
  v_pk_fma_f32 v[164:165], v[162:163], v[158:159], v[164:165] op_sel:[1,1,0] op_sel_hi:[1,0,1] neg_lo:[0,1,0]
  v_pk_mul_f32 v[134:135], v[132:133], v[126:127] op_sel:[0,0] op_sel_hi:[0,1]
  v_pk_mul_f32 v[166:167], v[164:165], v[158:159] op_sel:[0,0] op_sel_hi:[0,1]
  v_pk_fma_f32 v[134:135], v[132:133], v[126:127], v[134:135] op_sel:[1,1,0] op_sel_hi:[1,0,1] neg_lo:[0,1,0]
  v_pk_fma_f32 v[166:167], v[164:165], v[158:159], v[166:167] op_sel:[1,1,0] op_sel_hi:[1,0,1] neg_lo:[0,1,0]
  v_pk_mul_f32 v[136:137], v[134:135], v[126:127] op_sel:[0,0] op_sel_hi:[0,1]
  v_pk_mul_f32 v[168:169], v[166:167], v[158:159] op_sel:[0,0] op_sel_hi:[0,1]
  v_pk_fma_f32 v[136:137], v[134:135], v[126:127], v[136:137] op_sel:[1,1,0] op_sel_hi:[1,0,1] neg_lo:[0,1,0]
  v_pk_fma_f32 v[168:169], v[166:167], v[158:159], v[168:169] op_sel:[1,1,0] op_sel_hi:[1,0,1] neg_lo:[0,1,0]
  v_pk_mul_f32 v[138:139], v[136:137], v[126:127] op_sel:[0,0] op_sel_hi:[0,1]
  v_pk_mul_f32 v[170:171], v[168:169], v[158:159] op_sel:[0,0] op_sel_hi:[0,1]
  v_pk_fma_f32 v[138:139], v[136:137], v[126:127], v[138:139] op_sel:[1,1,0] op_sel_hi:[1,0,1] neg_lo:[0,1,0]
  v_pk_fma_f32 v[170:171], v[168:169], v[158:159], v[170:171] op_sel:[1,1,0] op_sel_hi:[1,0,1] neg_lo:[0,1,0]
  v_mov_b32 v20, 0x3f80
  v_mov_b32 v21, 0x3f80
  v_cvt_pk_bf16_f32 v22, v116, v117
  v_cvt_pk_bf16_f32 v23, v148, v149
  ds_write2_b64 v28, v[20:21], v[22:23] offset0:0 offset1:66
  v_pk_mul_f32 v[120:121], v[116:117], v[116:117] op_sel:[0,0] op_sel_hi:[0,1]
  v_pk_mul_f32 v[152:153], v[148:149], v[148:149] op_sel:[0,0] op_sel_hi:[0,1]
  v_pk_fma_f32 v[120:121], v[116:117], v[116:117], v[120:121] op_sel:[1,1,0] op_sel_hi:[1,0,1] neg_lo:[0,1,0]
  v_pk_fma_f32 v[152:153], v[148:149], v[148:149], v[152:153] op_sel:[1,1,0] op_sel_hi:[1,0,1] neg_lo:[0,1,0]
  v_cvt_pk_bf16_f32 v24, v120, v121
  v_cvt_pk_bf16_f32 v25, v152, v153
  v_pk_mul_f32 v[122:123], v[120:121], v[116:117] op_sel:[0,0] op_sel_hi:[0,1]
  v_pk_mul_f32 v[154:155], v[152:153], v[148:149] op_sel:[0,0] op_sel_hi:[0,1]
  v_pk_fma_f32 v[122:123], v[120:121], v[116:117], v[122:123] op_sel:[1,1,0] op_sel_hi:[1,0,1] neg_lo:[0,1,0]
  v_pk_fma_f32 v[154:155], v[152:153], v[148:149], v[154:155] op_sel:[1,1,0] op_sel_hi:[1,0,1] neg_lo:[0,1,0]
  v_cvt_pk_bf16_f32 v26, v122, v123
  v_cvt_pk_bf16_f32 v27, v154, v155
  ds_write2_b64 v28, v[24:25], v[26:27] offset0:132 offset1:198
  v_pk_mul_f32 v[120:121], v[122:123], v[116:117] op_sel:[0,0] op_sel_hi:[0,1]
  v_pk_mul_f32 v[152:153], v[154:155], v[148:149] op_sel:[0,0] op_sel_hi:[0,1]
  v_pk_fma_f32 v[120:121], v[122:123], v[116:117], v[120:121] op_sel:[1,1,0] op_sel_hi:[1,0,1] neg_lo:[0,1,0]
  v_pk_fma_f32 v[152:153], v[154:155], v[148:149], v[152:153] op_sel:[1,1,0] op_sel_hi:[1,0,1] neg_lo:[0,1,0]
  v_cvt_pk_bf16_f32 v20, v120, v121
  v_cvt_pk_bf16_f32 v21, v152, v153
  v_pk_mul_f32 v[122:123], v[120:121], v[116:117] op_sel:[0,0] op_sel_hi:[0,1]
  v_pk_mul_f32 v[154:155], v[152:153], v[148:149] op_sel:[0,0] op_sel_hi:[0,1]
  v_pk_fma_f32 v[122:123], v[120:121], v[116:117], v[122:123] op_sel:[1,1,0] op_sel_hi:[1,0,1] neg_lo:[0,1,0]
  v_pk_fma_f32 v[154:155], v[152:153], v[148:149], v[154:155] op_sel:[1,1,0] op_sel_hi:[1,0,1] neg_lo:[0,1,0]
  v_cvt_pk_bf16_f32 v22, v122, v123
  v_cvt_pk_bf16_f32 v23, v154, v155
  ds_write2_b64 v36, v[20:21], v[22:23] offset0:0 offset1:66
  v_pk_mul_f32 v[120:121], v[122:123], v[116:117] op_sel:[0,0] op_sel_hi:[0,1]
  v_pk_mul_f32 v[152:153], v[154:155], v[148:149] op_sel:[0,0] op_sel_hi:[0,1]
  v_pk_fma_f32 v[120:121], v[122:123], v[116:117], v[120:121] op_sel:[1,1,0] op_sel_hi:[1,0,1] neg_lo:[0,1,0]
  v_pk_fma_f32 v[152:153], v[154:155], v[148:149], v[152:153] op_sel:[1,1,0] op_sel_hi:[1,0,1] neg_lo:[0,1,0]
  v_cvt_pk_bf16_f32 v24, v120, v121
  v_cvt_pk_bf16_f32 v25, v152, v153
  v_pk_mul_f32 v[122:123], v[120:121], v[116:117] op_sel:[0,0] op_sel_hi:[0,1]
  v_pk_mul_f32 v[154:155], v[152:153], v[148:149] op_sel:[0,0] op_sel_hi:[0,1]
  v_pk_fma_f32 v[122:123], v[120:121], v[116:117], v[122:123] op_sel:[1,1,0] op_sel_hi:[1,0,1] neg_lo:[0,1,0]
  v_pk_fma_f32 v[154:155], v[152:153], v[148:149], v[154:155] op_sel:[1,1,0] op_sel_hi:[1,0,1] neg_lo:[0,1,0]
  v_cvt_pk_bf16_f32 v26, v122, v123
  v_cvt_pk_bf16_f32 v27, v154, v155
  ds_write2_b64 v36, v[24:25], v[26:27] offset0:132 offset1:198
  v_pk_mul_f32 v[120:121], v[122:123], v[116:117] op_sel:[0,0] op_sel_hi:[0,1]
  v_pk_mul_f32 v[152:153], v[154:155], v[148:149] op_sel:[0,0] op_sel_hi:[0,1]
  v_pk_fma_f32 v[120:121], v[122:123], v[116:117], v[120:121] op_sel:[1,1,0] op_sel_hi:[1,0,1] neg_lo:[0,1,0]
  v_pk_fma_f32 v[152:153], v[154:155], v[148:149], v[152:153] op_sel:[1,1,0] op_sel_hi:[1,0,1] neg_lo:[0,1,0]
  v_cvt_pk_bf16_f32 v20, v120, v121
  v_cvt_pk_bf16_f32 v21, v152, v153
  v_pk_mul_f32 v[122:123], v[120:121], v[116:117] op_sel:[0,0] op_sel_hi:[0,1]
  v_pk_mul_f32 v[154:155], v[152:153], v[148:149] op_sel:[0,0] op_sel_hi:[0,1]
  v_pk_fma_f32 v[122:123], v[120:121], v[116:117], v[122:123] op_sel:[1,1,0] op_sel_hi:[1,0,1] neg_lo:[0,1,0]
  v_pk_fma_f32 v[154:155], v[152:153], v[148:149], v[154:155] op_sel:[1,1,0] op_sel_hi:[1,0,1] neg_lo:[0,1,0]
  v_cvt_pk_bf16_f32 v22, v122, v123
  v_cvt_pk_bf16_f32 v23, v154, v155
  ds_write2_b64 v37, v[20:21], v[22:23] offset0:0 offset1:66
  v_pk_mul_f32 v[120:121], v[122:123], v[116:117] op_sel:[0,0] op_sel_hi:[0,1]
  v_pk_mul_f32 v[152:153], v[154:155], v[148:149] op_sel:[0,0] op_sel_hi:[0,1]
  v_pk_fma_f32 v[120:121], v[122:123], v[116:117], v[120:121] op_sel:[1,1,0] op_sel_hi:[1,0,1] neg_lo:[0,1,0]
  v_pk_fma_f32 v[152:153], v[154:155], v[148:149], v[152:153] op_sel:[1,1,0] op_sel_hi:[1,0,1] neg_lo:[0,1,0]
  v_cvt_pk_bf16_f32 v24, v120, v121
  v_cvt_pk_bf16_f32 v25, v152, v153
  v_pk_mul_f32 v[122:123], v[120:121], v[116:117] op_sel:[0,0] op_sel_hi:[0,1]
  v_pk_mul_f32 v[154:155], v[152:153], v[148:149] op_sel:[0,0] op_sel_hi:[0,1]
  v_pk_fma_f32 v[122:123], v[120:121], v[116:117], v[122:123] op_sel:[1,1,0] op_sel_hi:[1,0,1] neg_lo:[0,1,0]
  v_pk_fma_f32 v[154:155], v[152:153], v[148:149], v[154:155] op_sel:[1,1,0] op_sel_hi:[1,0,1] neg_lo:[0,1,0]
  v_cvt_pk_bf16_f32 v26, v122, v123
  v_cvt_pk_bf16_f32 v27, v154, v155
  ds_write2_b64 v37, v[24:25], v[26:27] offset0:132 offset1:198
  v_pk_mul_f32 v[120:121], v[122:123], v[116:117] op_sel:[0,0] op_sel_hi:[0,1]
  v_pk_mul_f32 v[152:153], v[154:155], v[148:149] op_sel:[0,0] op_sel_hi:[0,1]
  v_pk_fma_f32 v[120:121], v[122:123], v[116:117], v[120:121] op_sel:[1,1,0] op_sel_hi:[1,0,1] neg_lo:[0,1,0]
  v_pk_fma_f32 v[152:153], v[154:155], v[148:149], v[152:153] op_sel:[1,1,0] op_sel_hi:[1,0,1] neg_lo:[0,1,0]
  v_cvt_pk_bf16_f32 v20, v120, v121
  v_cvt_pk_bf16_f32 v21, v152, v153
  v_pk_mul_f32 v[122:123], v[120:121], v[116:117] op_sel:[0,0] op_sel_hi:[0,1]
  v_pk_mul_f32 v[154:155], v[152:153], v[148:149] op_sel:[0,0] op_sel_hi:[0,1]
  v_pk_fma_f32 v[122:123], v[120:121], v[116:117], v[122:123] op_sel:[1,1,0] op_sel_hi:[1,0,1] neg_lo:[0,1,0]
  v_pk_fma_f32 v[154:155], v[152:153], v[148:149], v[154:155] op_sel:[1,1,0] op_sel_hi:[1,0,1] neg_lo:[0,1,0]
  v_cvt_pk_bf16_f32 v22, v122, v123
  v_cvt_pk_bf16_f32 v23, v154, v155
  ds_write2_b64 v38, v[20:21], v[22:23] offset0:0 offset1:66
  v_pk_mul_f32 v[120:121], v[122:123], v[116:117] op_sel:[0,0] op_sel_hi:[0,1]
  v_pk_mul_f32 v[152:153], v[154:155], v[148:149] op_sel:[0,0] op_sel_hi:[0,1]
  v_pk_fma_f32 v[120:121], v[122:123], v[116:117], v[120:121] op_sel:[1,1,0] op_sel_hi:[1,0,1] neg_lo:[0,1,0]
  v_pk_fma_f32 v[152:153], v[154:155], v[148:149], v[152:153] op_sel:[1,1,0] op_sel_hi:[1,0,1] neg_lo:[0,1,0]
  v_cvt_pk_bf16_f32 v24, v120, v121
  v_cvt_pk_bf16_f32 v25, v152, v153
  v_pk_mul_f32 v[122:123], v[120:121], v[116:117] op_sel:[0,0] op_sel_hi:[0,1]
  v_pk_mul_f32 v[154:155], v[152:153], v[148:149] op_sel:[0,0] op_sel_hi:[0,1]
  v_pk_fma_f32 v[122:123], v[120:121], v[116:117], v[122:123] op_sel:[1,1,0] op_sel_hi:[1,0,1] neg_lo:[0,1,0]
  v_pk_fma_f32 v[154:155], v[152:153], v[148:149], v[154:155] op_sel:[1,1,0] op_sel_hi:[1,0,1] neg_lo:[0,1,0]
  v_cvt_pk_bf16_f32 v26, v122, v123
  v_cvt_pk_bf16_f32 v27, v154, v155
  ds_write2_b64 v38, v[24:25], v[26:27] offset0:132 offset1:198
  ds_read_b128 v[176:179], v29 offset:0
  ds_read_b128 v[180:183], v29 offset:64
  ds_read_b128 v[184:187], v29 offset:128
  ds_read_b128 v[188:191], v29 offset:192
  ds_read_b128 v[192:195], v29 offset:256
  ds_read_b128 v[196:199], v29 offset:320
  ds_read_b128 v[200:203], v29 offset:384
  ds_read_b128 v[204:207], v29 offset:448
  v_cvt_pk_bf16_f32 v24, v114, v115
  v_cvt_pk_bf16_f32 v25, v146, v147
  v_pk_mul_f32 v[124:125], v[114:115], v[126:127] op_sel:[0,0] op_sel_hi:[0,1]
  v_pk_mul_f32 v[156:157], v[146:147], v[158:159] op_sel:[0,0] op_sel_hi:[0,1]
  v_pk_fma_f32 v[124:125], v[114:115], v[126:127], v[124:125] op_sel:[1,1,0] op_sel_hi:[1,0,1] neg_lo:[0,1,0]
  v_pk_fma_f32 v[156:157], v[146:147], v[158:159], v[156:157] op_sel:[1,1,0] op_sel_hi:[1,0,1] neg_lo:[0,1,0]
  v_cvt_pk_bf16_f32 v26, v124, v125
  v_cvt_pk_bf16_f32 v27, v156, v157
  ds_write2_b64 v28, v[24:25], v[26:27] offset0:0 offset1:66
  v_pk_mul_f32 v[140:141], v[114:115], v[128:129] op_sel:[0,0] op_sel_hi:[0,1]
  v_pk_mul_f32 v[172:173], v[146:147], v[160:161] op_sel:[0,0] op_sel_hi:[0,1]
  v_pk_fma_f32 v[140:141], v[114:115], v[128:129], v[140:141] op_sel:[1,1,0] op_sel_hi:[1,0,1] neg_lo:[0,1,0]
  v_pk_fma_f32 v[172:173], v[146:147], v[160:161], v[172:173] op_sel:[1,1,0] op_sel_hi:[1,0,1] neg_lo:[0,1,0]
  v_cvt_pk_bf16_f32 v20, v140, v141
  v_cvt_pk_bf16_f32 v21, v172, v173
  v_pk_mul_f32 v[124:125], v[114:115], v[130:131] op_sel:[0,0] op_sel_hi:[0,1]
  v_pk_mul_f32 v[156:157], v[146:147], v[162:163] op_sel:[0,0] op_sel_hi:[0,1]
  v_pk_fma_f32 v[124:125], v[114:115], v[130:131], v[124:125] op_sel:[1,1,0] op_sel_hi:[1,0,1] neg_lo:[0,1,0]
  v_pk_fma_f32 v[156:157], v[146:147], v[162:163], v[156:157] op_sel:[1,1,0] op_sel_hi:[1,0,1] neg_lo:[0,1,0]
  v_cvt_pk_bf16_f32 v22, v124, v125
  v_cvt_pk_bf16_f32 v23, v156, v157
  ds_write2_b64 v28, v[20:21], v[22:23] offset0:132 offset1:198
  v_pk_mul_f32 v[140:141], v[114:115], v[132:133] op_sel:[0,0] op_sel_hi:[0,1]
  v_pk_mul_f32 v[172:173], v[146:147], v[164:165] op_sel:[0,0] op_sel_hi:[0,1]
  v_pk_fma_f32 v[140:141], v[114:115], v[132:133], v[140:141] op_sel:[1,1,0] op_sel_hi:[1,0,1] neg_lo:[0,1,0]
  v_pk_fma_f32 v[172:173], v[146:147], v[164:165], v[172:173] op_sel:[1,1,0] op_sel_hi:[1,0,1] neg_lo:[0,1,0]
  v_cvt_pk_bf16_f32 v24, v140, v141
  v_cvt_pk_bf16_f32 v25, v172, v173
  v_pk_mul_f32 v[124:125], v[114:115], v[134:135] op_sel:[0,0] op_sel_hi:[0,1]
  v_pk_mul_f32 v[156:157], v[146:147], v[166:167] op_sel:[0,0] op_sel_hi:[0,1]
  v_pk_fma_f32 v[124:125], v[114:115], v[134:135], v[124:125] op_sel:[1,1,0] op_sel_hi:[1,0,1] neg_lo:[0,1,0]
  v_pk_fma_f32 v[156:157], v[146:147], v[166:167], v[156:157] op_sel:[1,1,0] op_sel_hi:[1,0,1] neg_lo:[0,1,0]
  v_cvt_pk_bf16_f32 v26, v124, v125
  v_cvt_pk_bf16_f32 v27, v156, v157
  ds_write2_b64 v36, v[24:25], v[26:27] offset0:0 offset1:66
  v_pk_mul_f32 v[140:141], v[114:115], v[136:137] op_sel:[0,0] op_sel_hi:[0,1]
  v_pk_mul_f32 v[172:173], v[146:147], v[168:169] op_sel:[0,0] op_sel_hi:[0,1]
  v_pk_fma_f32 v[140:141], v[114:115], v[136:137], v[140:141] op_sel:[1,1,0] op_sel_hi:[1,0,1] neg_lo:[0,1,0]
  v_pk_fma_f32 v[172:173], v[146:147], v[168:169], v[172:173] op_sel:[1,1,0] op_sel_hi:[1,0,1] neg_lo:[0,1,0]
  v_cvt_pk_bf16_f32 v20, v140, v141
  v_cvt_pk_bf16_f32 v21, v172, v173
  v_pk_mul_f32 v[124:125], v[114:115], v[138:139] op_sel:[0,0] op_sel_hi:[0,1]
  v_pk_mul_f32 v[156:157], v[146:147], v[170:171] op_sel:[0,0] op_sel_hi:[0,1]
  v_pk_fma_f32 v[124:125], v[114:115], v[138:139], v[124:125] op_sel:[1,1,0] op_sel_hi:[1,0,1] neg_lo:[0,1,0]
  v_pk_fma_f32 v[156:157], v[146:147], v[170:171], v[156:157] op_sel:[1,1,0] op_sel_hi:[1,0,1] neg_lo:[0,1,0]
  v_cvt_pk_bf16_f32 v22, v124, v125
  v_cvt_pk_bf16_f32 v23, v156, v157
  ds_write2_b64 v36, v[20:21], v[22:23] offset0:132 offset1:198
  v_pk_mul_f32 v[120:121], v[114:115], v[118:119] op_sel:[0,0] op_sel_hi:[0,1]
  v_pk_mul_f32 v[152:153], v[146:147], v[150:151] op_sel:[0,0] op_sel_hi:[0,1]
  v_pk_fma_f32 v[120:121], v[114:115], v[118:119], v[120:121] op_sel:[1,1,0] op_sel_hi:[1,0,1] neg_lo:[0,1,0]
  v_pk_fma_f32 v[152:153], v[146:147], v[150:151], v[152:153] op_sel:[1,1,0] op_sel_hi:[1,0,1] neg_lo:[0,1,0]
  v_cvt_pk_bf16_f32 v24, v120, v121
  v_cvt_pk_bf16_f32 v25, v152, v153
  v_pk_mul_f32 v[140:141], v[120:121], v[126:127] op_sel:[0,0] op_sel_hi:[0,1]
  v_pk_mul_f32 v[172:173], v[152:153], v[158:159] op_sel:[0,0] op_sel_hi:[0,1]
  v_pk_fma_f32 v[140:141], v[120:121], v[126:127], v[140:141] op_sel:[1,1,0] op_sel_hi:[1,0,1] neg_lo:[0,1,0]
  v_pk_fma_f32 v[172:173], v[152:153], v[158:159], v[172:173] op_sel:[1,1,0] op_sel_hi:[1,0,1] neg_lo:[0,1,0]
  v_cvt_pk_bf16_f32 v26, v140, v141
  v_cvt_pk_bf16_f32 v27, v172, v173
  ds_write2_b64 v37, v[24:25], v[26:27] offset0:0 offset1:66
  v_pk_mul_f32 v[124:125], v[120:121], v[128:129] op_sel:[0,0] op_sel_hi:[0,1]
  v_pk_mul_f32 v[156:157], v[152:153], v[160:161] op_sel:[0,0] op_sel_hi:[0,1]
  v_pk_fma_f32 v[124:125], v[120:121], v[128:129], v[124:125] op_sel:[1,1,0] op_sel_hi:[1,0,1] neg_lo:[0,1,0]
  v_pk_fma_f32 v[156:157], v[152:153], v[160:161], v[156:157] op_sel:[1,1,0] op_sel_hi:[1,0,1] neg_lo:[0,1,0]
  v_cvt_pk_bf16_f32 v20, v124, v125
  v_cvt_pk_bf16_f32 v21, v156, v157
  v_pk_mul_f32 v[140:141], v[120:121], v[130:131] op_sel:[0,0] op_sel_hi:[0,1]
  v_pk_mul_f32 v[172:173], v[152:153], v[162:163] op_sel:[0,0] op_sel_hi:[0,1]
  v_pk_fma_f32 v[140:141], v[120:121], v[130:131], v[140:141] op_sel:[1,1,0] op_sel_hi:[1,0,1] neg_lo:[0,1,0]
  v_pk_fma_f32 v[172:173], v[152:153], v[162:163], v[172:173] op_sel:[1,1,0] op_sel_hi:[1,0,1] neg_lo:[0,1,0]
  v_cvt_pk_bf16_f32 v22, v140, v141
  v_cvt_pk_bf16_f32 v23, v172, v173
  ds_write2_b64 v37, v[20:21], v[22:23] offset0:132 offset1:198
  v_pk_mul_f32 v[124:125], v[120:121], v[132:133] op_sel:[0,0] op_sel_hi:[0,1]
  v_pk_mul_f32 v[156:157], v[152:153], v[164:165] op_sel:[0,0] op_sel_hi:[0,1]
  v_pk_fma_f32 v[124:125], v[120:121], v[132:133], v[124:125] op_sel:[1,1,0] op_sel_hi:[1,0,1] neg_lo:[0,1,0]
  v_pk_fma_f32 v[156:157], v[152:153], v[164:165], v[156:157] op_sel:[1,1,0] op_sel_hi:[1,0,1] neg_lo:[0,1,0]
  v_cvt_pk_bf16_f32 v24, v124, v125
  v_cvt_pk_bf16_f32 v25, v156, v157
  v_pk_mul_f32 v[140:141], v[120:121], v[134:135] op_sel:[0,0] op_sel_hi:[0,1]
  v_pk_mul_f32 v[172:173], v[152:153], v[166:167] op_sel:[0,0] op_sel_hi:[0,1]
  v_pk_fma_f32 v[140:141], v[120:121], v[134:135], v[140:141] op_sel:[1,1,0] op_sel_hi:[1,0,1] neg_lo:[0,1,0]
  v_pk_fma_f32 v[172:173], v[152:153], v[166:167], v[172:173] op_sel:[1,1,0] op_sel_hi:[1,0,1] neg_lo:[0,1,0]
  v_cvt_pk_bf16_f32 v26, v140, v141
  v_cvt_pk_bf16_f32 v27, v172, v173
  ds_write2_b64 v38, v[24:25], v[26:27] offset0:0 offset1:66
  v_pk_mul_f32 v[124:125], v[120:121], v[136:137] op_sel:[0,0] op_sel_hi:[0,1]
  v_pk_mul_f32 v[156:157], v[152:153], v[168:169] op_sel:[0,0] op_sel_hi:[0,1]
  v_pk_fma_f32 v[124:125], v[120:121], v[136:137], v[124:125] op_sel:[1,1,0] op_sel_hi:[1,0,1] neg_lo:[0,1,0]
  v_pk_fma_f32 v[156:157], v[152:153], v[168:169], v[156:157] op_sel:[1,1,0] op_sel_hi:[1,0,1] neg_lo:[0,1,0]
  v_cvt_pk_bf16_f32 v20, v124, v125
  v_cvt_pk_bf16_f32 v21, v156, v157
  v_pk_mul_f32 v[140:141], v[120:121], v[138:139] op_sel:[0,0] op_sel_hi:[0,1]
  v_pk_mul_f32 v[172:173], v[152:153], v[170:171] op_sel:[0,0] op_sel_hi:[0,1]
  v_pk_fma_f32 v[140:141], v[120:121], v[138:139], v[140:141] op_sel:[1,1,0] op_sel_hi:[1,0,1] neg_lo:[0,1,0]
  v_pk_fma_f32 v[172:173], v[152:153], v[170:171], v[172:173] op_sel:[1,1,0] op_sel_hi:[1,0,1] neg_lo:[0,1,0]
  v_cvt_pk_bf16_f32 v22, v140, v141
  v_cvt_pk_bf16_f32 v23, v172, v173
  ds_write2_b64 v38, v[20:21], v[22:23] offset0:132 offset1:198
  ds_read_b128 v[208:211], v29 offset:0
  ds_read_b128 v[212:215], v29 offset:64
  ds_read_b128 v[216:219], v29 offset:128
  ds_read_b128 v[220:223], v29 offset:192
  ds_read_b128 v[224:227], v29 offset:256
  ds_read_b128 v[228:231], v29 offset:320
  ds_read_b128 v[232:235], v29 offset:384
  ds_read_b128 v[236:239], v29 offset:448
  v_pk_mul_f32 v[122:123], v[120:121], v[118:119] op_sel:[0,0] op_sel_hi:[0,1]
  v_pk_mul_f32 v[154:155], v[152:153], v[150:151] op_sel:[0,0] op_sel_hi:[0,1]
  v_pk_fma_f32 v[122:123], v[120:121], v[118:119], v[122:123] op_sel:[1,1,0] op_sel_hi:[1,0,1] neg_lo:[0,1,0]
  v_pk_fma_f32 v[154:155], v[152:153], v[150:151], v[154:155] op_sel:[1,1,0] op_sel_hi:[1,0,1] neg_lo:[0,1,0]
  v_cvt_pk_bf16_f32 v20, v122, v123
  v_cvt_pk_bf16_f32 v21, v154, v155
  v_pk_mul_f32 v[124:125], v[122:123], v[128:129] op_sel:[0,0] op_sel_hi:[0,1]
  v_pk_mul_f32 v[156:157], v[154:155], v[160:161] op_sel:[0,0] op_sel_hi:[0,1]
  v_pk_fma_f32 v[124:125], v[122:123], v[128:129], v[124:125] op_sel:[1,1,0] op_sel_hi:[1,0,1] neg_lo:[0,1,0]
  v_pk_fma_f32 v[156:157], v[154:155], v[160:161], v[156:157] op_sel:[1,1,0] op_sel_hi:[1,0,1] neg_lo:[0,1,0]
  v_cvt_pk_bf16_f32 v22, v124, v125
  v_cvt_pk_bf16_f32 v23, v156, v157
  ds_write2_b64 v28, v[20:21], v[22:23] offset0:0 offset1:66
  v_pk_mul_f32 v[140:141], v[122:123], v[132:133] op_sel:[0,0] op_sel_hi:[0,1]
  v_pk_mul_f32 v[172:173], v[154:155], v[164:165] op_sel:[0,0] op_sel_hi:[0,1]
  v_pk_fma_f32 v[140:141], v[122:123], v[132:133], v[140:141] op_sel:[1,1,0] op_sel_hi:[1,0,1] neg_lo:[0,1,0]
  v_pk_fma_f32 v[172:173], v[154:155], v[164:165], v[172:173] op_sel:[1,1,0] op_sel_hi:[1,0,1] neg_lo:[0,1,0]
  v_cvt_pk_bf16_f32 v24, v140, v141
  v_cvt_pk_bf16_f32 v25, v172, v173
  v_pk_mul_f32 v[124:125], v[122:123], v[136:137] op_sel:[0,0] op_sel_hi:[0,1]
  v_pk_mul_f32 v[156:157], v[154:155], v[168:169] op_sel:[0,0] op_sel_hi:[0,1]
  v_pk_fma_f32 v[124:125], v[122:123], v[136:137], v[124:125] op_sel:[1,1,0] op_sel_hi:[1,0,1] neg_lo:[0,1,0]
  v_pk_fma_f32 v[156:157], v[154:155], v[168:169], v[156:157] op_sel:[1,1,0] op_sel_hi:[1,0,1] neg_lo:[0,1,0]
  v_cvt_pk_bf16_f32 v26, v124, v125
  v_cvt_pk_bf16_f32 v27, v156, v157
  ds_write2_b64 v28, v[24:25], v[26:27] offset0:132 offset1:198
  s_waitcnt lgkmcnt(9)
  v_mfma_f32_16x16x32_bf16 v[8:11], v[208:211], v[176:179], 0
  s_waitcnt lgkmcnt(8)
  v_mfma_f32_16x16x32_bf16 v[8:11], v[212:215], v[180:183], v[8:11]
  s_waitcnt lgkmcnt(7)
  v_mfma_f32_16x16x32_bf16 v[8:11], v[216:219], v[184:187], v[8:11]
  s_waitcnt lgkmcnt(6)
  v_mfma_f32_16x16x32_bf16 v[8:11], v[220:223], v[188:191], v[8:11]
  s_waitcnt lgkmcnt(5)
  v_mfma_f32_16x16x32_bf16 v[8:11], v[224:227], v[192:195], v[8:11]
  s_waitcnt lgkmcnt(4)
  v_mfma_f32_16x16x32_bf16 v[8:11], v[228:231], v[196:199], v[8:11]
  s_waitcnt lgkmcnt(3)
  v_mfma_f32_16x16x32_bf16 v[8:11], v[232:235], v[200:203], v[8:11]
  s_waitcnt lgkmcnt(2)
  v_mfma_f32_16x16x32_bf16 v[8:11], v[236:239], v[204:207], v[8:11]
  v_pk_mul_f32 v[120:121], v[122:123], v[118:119] op_sel:[0,0] op_sel_hi:[0,1]
  v_pk_mul_f32 v[152:153], v[154:155], v[150:151] op_sel:[0,0] op_sel_hi:[0,1]
  v_pk_fma_f32 v[120:121], v[122:123], v[118:119], v[120:121] op_sel:[1,1,0] op_sel_hi:[1,0,1] neg_lo:[0,1,0]
  v_pk_fma_f32 v[152:153], v[154:155], v[150:151], v[152:153] op_sel:[1,1,0] op_sel_hi:[1,0,1] neg_lo:[0,1,0]
  v_cvt_pk_bf16_f32 v20, v120, v121
  v_cvt_pk_bf16_f32 v21, v152, v153
  v_pk_mul_f32 v[140:141], v[120:121], v[128:129] op_sel:[0,0] op_sel_hi:[0,1]
  v_pk_mul_f32 v[172:173], v[152:153], v[160:161] op_sel:[0,0] op_sel_hi:[0,1]
  v_pk_fma_f32 v[140:141], v[120:121], v[128:129], v[140:141] op_sel:[1,1,0] op_sel_hi:[1,0,1] neg_lo:[0,1,0]
  v_pk_fma_f32 v[172:173], v[152:153], v[160:161], v[172:173] op_sel:[1,1,0] op_sel_hi:[1,0,1] neg_lo:[0,1,0]
  v_cvt_pk_bf16_f32 v22, v140, v141
  v_cvt_pk_bf16_f32 v23, v172, v173
  ds_write2_b64 v36, v[20:21], v[22:23] offset0:0 offset1:66
  v_pk_mul_f32 v[124:125], v[120:121], v[132:133] op_sel:[0,0] op_sel_hi:[0,1]
  v_pk_mul_f32 v[156:157], v[152:153], v[164:165] op_sel:[0,0] op_sel_hi:[0,1]
  v_pk_fma_f32 v[124:125], v[120:121], v[132:133], v[124:125] op_sel:[1,1,0] op_sel_hi:[1,0,1] neg_lo:[0,1,0]
  v_pk_fma_f32 v[156:157], v[152:153], v[164:165], v[156:157] op_sel:[1,1,0] op_sel_hi:[1,0,1] neg_lo:[0,1,0]
  v_cvt_pk_bf16_f32 v24, v124, v125
  v_cvt_pk_bf16_f32 v25, v156, v157
  v_pk_mul_f32 v[140:141], v[120:121], v[136:137] op_sel:[0,0] op_sel_hi:[0,1]
  v_pk_mul_f32 v[172:173], v[152:153], v[168:169] op_sel:[0,0] op_sel_hi:[0,1]
  v_pk_fma_f32 v[140:141], v[120:121], v[136:137], v[140:141] op_sel:[1,1,0] op_sel_hi:[1,0,1] neg_lo:[0,1,0]
  v_pk_fma_f32 v[172:173], v[152:153], v[168:169], v[172:173] op_sel:[1,1,0] op_sel_hi:[1,0,1] neg_lo:[0,1,0]
  v_cvt_pk_bf16_f32 v26, v140, v141
  v_cvt_pk_bf16_f32 v27, v172, v173
  ds_write2_b64 v36, v[24:25], v[26:27] offset0:132 offset1:198
  v_pk_mul_f32 v[122:123], v[120:121], v[118:119] op_sel:[0,0] op_sel_hi:[0,1]
  v_pk_mul_f32 v[154:155], v[152:153], v[150:151] op_sel:[0,0] op_sel_hi:[0,1]
  v_pk_fma_f32 v[122:123], v[120:121], v[118:119], v[122:123] op_sel:[1,1,0] op_sel_hi:[1,0,1] neg_lo:[0,1,0]
  v_pk_fma_f32 v[154:155], v[152:153], v[150:151], v[154:155] op_sel:[1,1,0] op_sel_hi:[1,0,1] neg_lo:[0,1,0]
  v_cvt_pk_bf16_f32 v20, v122, v123
  v_cvt_pk_bf16_f32 v21, v154, v155
  v_pk_mul_f32 v[124:125], v[122:123], v[132:133] op_sel:[0,0] op_sel_hi:[0,1]
  v_pk_mul_f32 v[156:157], v[154:155], v[164:165] op_sel:[0,0] op_sel_hi:[0,1]
  v_pk_fma_f32 v[124:125], v[122:123], v[132:133], v[124:125] op_sel:[1,1,0] op_sel_hi:[1,0,1] neg_lo:[0,1,0]
  v_pk_fma_f32 v[156:157], v[154:155], v[164:165], v[156:157] op_sel:[1,1,0] op_sel_hi:[1,0,1] neg_lo:[0,1,0]
  v_cvt_pk_bf16_f32 v22, v124, v125
  v_cvt_pk_bf16_f32 v23, v156, v157
  ds_write2_b64 v37, v[20:21], v[22:23] offset0:0 offset1:66
  v_pk_mul_f32 v[120:121], v[122:123], v[118:119] op_sel:[0,0] op_sel_hi:[0,1]
  v_pk_mul_f32 v[152:153], v[154:155], v[150:151] op_sel:[0,0] op_sel_hi:[0,1]
  v_pk_fma_f32 v[120:121], v[122:123], v[118:119], v[120:121] op_sel:[1,1,0] op_sel_hi:[1,0,1] neg_lo:[0,1,0]
  v_pk_fma_f32 v[152:153], v[154:155], v[150:151], v[152:153] op_sel:[1,1,0] op_sel_hi:[1,0,1] neg_lo:[0,1,0]
  v_cvt_pk_bf16_f32 v24, v120, v121
  v_cvt_pk_bf16_f32 v25, v152, v153
  v_pk_mul_f32 v[140:141], v[120:121], v[132:133] op_sel:[0,0] op_sel_hi:[0,1]
  v_pk_mul_f32 v[172:173], v[152:153], v[164:165] op_sel:[0,0] op_sel_hi:[0,1]
  v_pk_fma_f32 v[140:141], v[120:121], v[132:133], v[140:141] op_sel:[1,1,0] op_sel_hi:[1,0,1] neg_lo:[0,1,0]
  v_pk_fma_f32 v[172:173], v[152:153], v[164:165], v[172:173] op_sel:[1,1,0] op_sel_hi:[1,0,1] neg_lo:[0,1,0]
  v_cvt_pk_bf16_f32 v26, v140, v141
  v_cvt_pk_bf16_f32 v27, v172, v173
  ds_write2_b64 v37, v[24:25], v[26:27] offset0:132 offset1:198
  v_pk_mul_f32 v[122:123], v[120:121], v[118:119] op_sel:[0,0] op_sel_hi:[0,1]
  v_pk_mul_f32 v[154:155], v[152:153], v[150:151] op_sel:[0,0] op_sel_hi:[0,1]
  v_pk_fma_f32 v[122:123], v[120:121], v[118:119], v[122:123] op_sel:[1,1,0] op_sel_hi:[1,0,1] neg_lo:[0,1,0]
  v_pk_fma_f32 v[154:155], v[152:153], v[150:151], v[154:155] op_sel:[1,1,0] op_sel_hi:[1,0,1] neg_lo:[0,1,0]
  v_cvt_pk_bf16_f32 v20, v122, v123
  v_cvt_pk_bf16_f32 v21, v154, v155
  v_pk_mul_f32 v[124:125], v[122:123], v[132:133] op_sel:[0,0] op_sel_hi:[0,1]
  v_pk_mul_f32 v[156:157], v[154:155], v[164:165] op_sel:[0,0] op_sel_hi:[0,1]
  v_pk_fma_f32 v[124:125], v[122:123], v[132:133], v[124:125] op_sel:[1,1,0] op_sel_hi:[1,0,1] neg_lo:[0,1,0]
  v_pk_fma_f32 v[156:157], v[154:155], v[164:165], v[156:157] op_sel:[1,1,0] op_sel_hi:[1,0,1] neg_lo:[0,1,0]
  v_cvt_pk_bf16_f32 v22, v124, v125
  v_cvt_pk_bf16_f32 v23, v156, v157
  ds_write2_b64 v38, v[20:21], v[22:23] offset0:0 offset1:66
  v_pk_mul_f32 v[120:121], v[122:123], v[118:119] op_sel:[0,0] op_sel_hi:[0,1]
  v_pk_mul_f32 v[152:153], v[154:155], v[150:151] op_sel:[0,0] op_sel_hi:[0,1]
  v_pk_fma_f32 v[120:121], v[122:123], v[118:119], v[120:121] op_sel:[1,1,0] op_sel_hi:[1,0,1] neg_lo:[0,1,0]
  v_pk_fma_f32 v[152:153], v[154:155], v[150:151], v[152:153] op_sel:[1,1,0] op_sel_hi:[1,0,1] neg_lo:[0,1,0]
  v_cvt_pk_bf16_f32 v24, v120, v121
  v_cvt_pk_bf16_f32 v25, v152, v153
  v_pk_mul_f32 v[140:141], v[120:121], v[132:133] op_sel:[0,0] op_sel_hi:[0,1]
  v_pk_mul_f32 v[172:173], v[152:153], v[164:165] op_sel:[0,0] op_sel_hi:[0,1]
  v_pk_fma_f32 v[140:141], v[120:121], v[132:133], v[140:141] op_sel:[1,1,0] op_sel_hi:[1,0,1] neg_lo:[0,1,0]
  v_pk_fma_f32 v[172:173], v[152:153], v[164:165], v[172:173] op_sel:[1,1,0] op_sel_hi:[1,0,1] neg_lo:[0,1,0]
  v_cvt_pk_bf16_f32 v26, v140, v141
  v_cvt_pk_bf16_f32 v27, v172, v173
  ds_write2_b64 v38, v[24:25], v[26:27] offset0:132 offset1:198
  ds_read_b128 v[208:211], v29 offset:0
  ds_read_b128 v[212:215], v29 offset:64
  ds_read_b128 v[216:219], v29 offset:128
  ds_read_b128 v[220:223], v29 offset:192
  ds_read_b128 v[224:227], v29 offset:256
  ds_read_b128 v[228:231], v29 offset:320
  ds_read_b128 v[232:235], v29 offset:384
  ds_read_b128 v[236:239], v29 offset:448
  v_pk_mul_f32 v[122:123], v[120:121], v[118:119] op_sel:[0,0] op_sel_hi:[0,1]
  v_pk_mul_f32 v[154:155], v[152:153], v[150:151] op_sel:[0,0] op_sel_hi:[0,1]
  v_pk_fma_f32 v[122:123], v[120:121], v[118:119], v[122:123] op_sel:[1,1,0] op_sel_hi:[1,0,1] neg_lo:[0,1,0]
  v_pk_fma_f32 v[154:155], v[152:153], v[150:151], v[154:155] op_sel:[1,1,0] op_sel_hi:[1,0,1] neg_lo:[0,1,0]
  v_cvt_pk_bf16_f32 v24, v122, v123
  v_cvt_pk_bf16_f32 v25, v154, v155
  v_pk_mul_f32 v[120:121], v[122:123], v[118:119] op_sel:[0,0] op_sel_hi:[0,1]
  v_pk_mul_f32 v[152:153], v[154:155], v[150:151] op_sel:[0,0] op_sel_hi:[0,1]
  v_pk_fma_f32 v[120:121], v[122:123], v[118:119], v[120:121] op_sel:[1,1,0] op_sel_hi:[1,0,1] neg_lo:[0,1,0]
  v_pk_fma_f32 v[152:153], v[154:155], v[150:151], v[152:153] op_sel:[1,1,0] op_sel_hi:[1,0,1] neg_lo:[0,1,0]
  v_cvt_pk_bf16_f32 v26, v120, v121
  v_cvt_pk_bf16_f32 v27, v152, v153
  ds_write2_b64 v28, v[24:25], v[26:27] offset0:0 offset1:66
  v_pk_mul_f32 v[122:123], v[120:121], v[118:119] op_sel:[0,0] op_sel_hi:[0,1]
  v_pk_mul_f32 v[154:155], v[152:153], v[150:151] op_sel:[0,0] op_sel_hi:[0,1]
  v_pk_fma_f32 v[122:123], v[120:121], v[118:119], v[122:123] op_sel:[1,1,0] op_sel_hi:[1,0,1] neg_lo:[0,1,0]
  v_pk_fma_f32 v[154:155], v[152:153], v[150:151], v[154:155] op_sel:[1,1,0] op_sel_hi:[1,0,1] neg_lo:[0,1,0]
  v_cvt_pk_bf16_f32 v20, v122, v123
  v_cvt_pk_bf16_f32 v21, v154, v155
  v_pk_mul_f32 v[120:121], v[122:123], v[118:119] op_sel:[0,0] op_sel_hi:[0,1]
  v_pk_mul_f32 v[152:153], v[154:155], v[150:151] op_sel:[0,0] op_sel_hi:[0,1]
  v_pk_fma_f32 v[120:121], v[122:123], v[118:119], v[120:121] op_sel:[1,1,0] op_sel_hi:[1,0,1] neg_lo:[0,1,0]
  v_pk_fma_f32 v[152:153], v[154:155], v[150:151], v[152:153] op_sel:[1,1,0] op_sel_hi:[1,0,1] neg_lo:[0,1,0]
  v_cvt_pk_bf16_f32 v22, v120, v121
  v_cvt_pk_bf16_f32 v23, v152, v153
  ds_write2_b64 v28, v[20:21], v[22:23] offset0:132 offset1:198
  s_waitcnt lgkmcnt(9)
  v_mfma_f32_16x16x32_bf16 v[12:15], v[208:211], v[176:179], 0
  s_waitcnt lgkmcnt(8)
  v_mfma_f32_16x16x32_bf16 v[12:15], v[212:215], v[180:183], v[12:15]
  s_waitcnt lgkmcnt(7)
  v_mfma_f32_16x16x32_bf16 v[12:15], v[216:219], v[184:187], v[12:15]
  s_waitcnt lgkmcnt(6)
  v_mfma_f32_16x16x32_bf16 v[12:15], v[220:223], v[188:191], v[12:15]
  s_waitcnt lgkmcnt(5)
  v_mfma_f32_16x16x32_bf16 v[12:15], v[224:227], v[192:195], v[12:15]
  s_waitcnt lgkmcnt(4)
  v_mfma_f32_16x16x32_bf16 v[12:15], v[228:231], v[196:199], v[12:15]
  s_waitcnt lgkmcnt(3)
  v_mfma_f32_16x16x32_bf16 v[12:15], v[232:235], v[200:203], v[12:15]
  s_waitcnt lgkmcnt(2)
  v_mfma_f32_16x16x32_bf16 v[12:15], v[236:239], v[204:207], v[12:15]
  v_pk_mul_f32 v[122:123], v[120:121], v[118:119] op_sel:[0,0] op_sel_hi:[0,1]
  v_pk_mul_f32 v[154:155], v[152:153], v[150:151] op_sel:[0,0] op_sel_hi:[0,1]
  v_pk_fma_f32 v[122:123], v[120:121], v[118:119], v[122:123] op_sel:[1,1,0] op_sel_hi:[1,0,1] neg_lo:[0,1,0]
  v_pk_fma_f32 v[154:155], v[152:153], v[150:151], v[154:155] op_sel:[1,1,0] op_sel_hi:[1,0,1] neg_lo:[0,1,0]
  v_cvt_pk_bf16_f32 v24, v122, v123
  v_cvt_pk_bf16_f32 v25, v154, v155
  v_pk_mul_f32 v[120:121], v[122:123], v[118:119] op_sel:[0,0] op_sel_hi:[0,1]
  v_pk_mul_f32 v[152:153], v[154:155], v[150:151] op_sel:[0,0] op_sel_hi:[0,1]
  v_pk_fma_f32 v[120:121], v[122:123], v[118:119], v[120:121] op_sel:[1,1,0] op_sel_hi:[1,0,1] neg_lo:[0,1,0]
  v_pk_fma_f32 v[152:153], v[154:155], v[150:151], v[152:153] op_sel:[1,1,0] op_sel_hi:[1,0,1] neg_lo:[0,1,0]
  v_cvt_pk_bf16_f32 v26, v120, v121
  v_cvt_pk_bf16_f32 v27, v152, v153
  ds_write2_b64 v36, v[24:25], v[26:27] offset0:0 offset1:66
  v_pk_mul_f32 v[122:123], v[120:121], v[118:119] op_sel:[0,0] op_sel_hi:[0,1]
  v_pk_mul_f32 v[154:155], v[152:153], v[150:151] op_sel:[0,0] op_sel_hi:[0,1]
  v_pk_fma_f32 v[122:123], v[120:121], v[118:119], v[122:123] op_sel:[1,1,0] op_sel_hi:[1,0,1] neg_lo:[0,1,0]
  v_pk_fma_f32 v[154:155], v[152:153], v[150:151], v[154:155] op_sel:[1,1,0] op_sel_hi:[1,0,1] neg_lo:[0,1,0]
  v_cvt_pk_bf16_f32 v20, v122, v123
  v_cvt_pk_bf16_f32 v21, v154, v155
  v_pk_mul_f32 v[120:121], v[122:123], v[118:119] op_sel:[0,0] op_sel_hi:[0,1]
  v_pk_mul_f32 v[152:153], v[154:155], v[150:151] op_sel:[0,0] op_sel_hi:[0,1]
  v_pk_fma_f32 v[120:121], v[122:123], v[118:119], v[120:121] op_sel:[1,1,0] op_sel_hi:[1,0,1] neg_lo:[0,1,0]
  v_pk_fma_f32 v[152:153], v[154:155], v[150:151], v[152:153] op_sel:[1,1,0] op_sel_hi:[1,0,1] neg_lo:[0,1,0]
  v_cvt_pk_bf16_f32 v22, v120, v121
  v_cvt_pk_bf16_f32 v23, v152, v153
  ds_write2_b64 v36, v[20:21], v[22:23] offset0:132 offset1:198
  v_pk_mul_f32 v[122:123], v[120:121], v[118:119] op_sel:[0,0] op_sel_hi:[0,1]
  v_pk_mul_f32 v[154:155], v[152:153], v[150:151] op_sel:[0,0] op_sel_hi:[0,1]
  v_pk_fma_f32 v[122:123], v[120:121], v[118:119], v[122:123] op_sel:[1,1,0] op_sel_hi:[1,0,1] neg_lo:[0,1,0]
  v_pk_fma_f32 v[154:155], v[152:153], v[150:151], v[154:155] op_sel:[1,1,0] op_sel_hi:[1,0,1] neg_lo:[0,1,0]
  v_cvt_pk_bf16_f32 v24, v122, v123
  v_cvt_pk_bf16_f32 v25, v154, v155
  ds_write_b64 v28, v[24:25] offset:4224
  ds_read_b128 v[208:211], v29 offset:0
  ds_read_b128 v[212:215], v29 offset:64
  ds_read_b128 v[216:219], v29 offset:128
  ds_read_b128 v[220:223], v29 offset:192
  ds_read_b128 v[224:227], v29 offset:256
  ds_read_b128 v[228:231], v29 offset:320
  ds_read_b128 v[232:235], v29 offset:384
  ds_read_b128 v[236:239], v29 offset:448
  s_waitcnt lgkmcnt(7)
  v_mfma_f32_16x16x32_bf16 v[16:19], v[208:211], v[176:179], 0
  s_waitcnt lgkmcnt(6)
  v_mfma_f32_16x16x32_bf16 v[16:19], v[212:215], v[180:183], v[16:19]
  s_waitcnt lgkmcnt(5)
  v_mfma_f32_16x16x32_bf16 v[16:19], v[216:219], v[184:187], v[16:19]
  s_waitcnt lgkmcnt(4)
  v_mfma_f32_16x16x32_bf16 v[16:19], v[220:223], v[188:191], v[16:19]
  s_waitcnt lgkmcnt(3)
  v_mfma_f32_16x16x32_bf16 v[16:19], v[224:227], v[192:195], v[16:19]
  s_waitcnt lgkmcnt(2)
  v_mfma_f32_16x16x32_bf16 v[16:19], v[228:231], v[196:199], v[16:19]
  s_waitcnt lgkmcnt(1)
  v_mfma_f32_16x16x32_bf16 v[16:19], v[232:235], v[200:203], v[16:19]
  s_waitcnt lgkmcnt(0)
  v_mfma_f32_16x16x32_bf16 v[16:19], v[236:239], v[204:207], v[16:19]
  v_cvt_pk_bf16_f32 v72, v15, v14
  v_cvt_pk_bf16_f32 v73, v14, v14
  v_cvt_pk_bf16_f32 v74, v13, v12
  v_cvt_pk_bf16_f32 v75, v12, v12
  v_cvt_pk_bf16_f32 v76, v14, v13
  v_cvt_pk_bf16_f32 v78, v12, v13
  v_cvt_pk_bf16_f32 v79, v14, v15
  v_mov_b32 v80, v75
  v_mov_b32 v81, v75
  s_mov_b32 exec_hi, 0
  ds_write2_b64 v65, v[72:73], v[74:75] offset0:19 offset1:20
  ds_write_b16 v65, v72 offset:1498
  ds_write_b32 v65, v73 offset:1500
  ds_write_b32 v65, v76 offset:1504
  ds_write_b32 v65, v75 offset:1508
  ds_write_b16 v65, v75 offset:1512
  s_mov_b32 exec_lo, 0
  s_mov_b32 exec_hi, -1
  ds_write_b16 v66, v78 offset:2592
  ds_write_b16_d16_hi v67, v78 offset:2592
  ds_write_b16 v66, v79 offset:2576
  ds_write_b16_d16_hi v67, v79 offset:2576
  ds_write_b16 v66, v78 offset:3554
  ds_write_b16_d16_hi v67, v78 offset:3554
  ds_write_b16 v66, v79 offset:3538
  ds_write_b16_d16_hi v67, v79 offset:3538
  s_mov_b32 exec_hi, 1
  ds_write_b64 v69, v[80:81] offset:160
  ds_write_b16 v69, v80 offset:1506
  ds_write_b32 v69, v80 offset:1508
  ds_write_b16 v69, v80 offset:1512
  ds_write_b16 v69, v32 offset:3218
  ds_write_b16 v69, v32 offset:4180
  s_mov_b64 exec, 1
  s_waitcnt vmcnt(0)
  v_lshlrev_b32 v5, 16, v109
  v_add_f32 v8, v8, v5
  s_mov_b64 exec, -1
  v_cvt_pk_bf16_f32 v82, v11, v10
  v_cvt_pk_bf16_f32 v83, v9, v8
  v_cvt_pk_bf16_f32 v84, v10, v9
  ds_write_b64 v64, v[82:83] offset:2016
  ds_write_b16 v64, v82 offset:670
  ds_write_b32 v64, v84 offset:672
  ds_write_b16_d16_hi v64, v83 offset:676
  v_cvt_pk_bf16_f32 v86, v16, v17
  v_cvt_pk_bf16_f32 v87, v18, v19
  v_cvt_pk_bf16_f32 v88, v16, v16
  s_mov_b32 exec_hi, 0xffff
  ds_write_b16 v68, v86 offset:3152
  ds_write_b16 v68, v86 offset:4114
  s_mov_b32 exec_hi, 0
  ds_write_b16_d16_hi v68, v86 offset:3136
  ds_write_b16 v68, v87 offset:3120
  ds_write_b16_d16_hi v68, v87 offset:3104
  ds_write_b16_d16_hi v68, v86 offset:4098
  ds_write_b16 v68, v87 offset:4082
  ds_write_b16_d16_hi v68, v87 offset:4066
  s_mov_b64 exec, 1
  ds_write_b16 v69, v32 offset:3602
  ds_write_b16 v69, v32 offset:4564
  ds_write_b16 v69, v88 offset:3154
  ds_write_b16 v69, v88 offset:4116
  ds_write_b32 v69, v88 offset:60
  ds_write_b16 v69, v88 offset:1406
  ds_write_b16 v69, v88 offset:1408
  s_mov_b64 exec, -1
  s_waitcnt vmcnt(0) lgkmcnt(0)
  s_branch L_Aconv
L_A3:
  s_lshl_b32 s89, s62, 3
  s_lshr_b32 s84, s63, 2
  s_add_u32 s89, s89, s84
  s_mul_i32 s89, s89, 9
  s_and_b32 s84, s63, 3
  s_lshl_b32 s84, s84, 1
  s_add_u32 s84, s84, s61
  s_cmp_lt_u32 s61, 2
  s_cselect_b32 s84, s84, 8
  s_add_u32 s86, s89, s84
  s_waitcnt lgkmcnt(0)
  s_load_dword s60, s[42:43], 0
  s_mov_b64 s[44:45], s[42:43]
  s_mov_b32 s46, 13631488
  s_mov_b32 s47, 0x20000
  s_movk_i32 s85, 1008
  v_add_u32 v110, 0, v1
  v_mul_u32_u24 v110, 7282, v110
  v_lshrrev_b32 v110, 16, v110
  v_mad_u32_u24 v110, v110, s85, v4
  v_add_u32 v111, 64, v1
  v_mul_u32_u24 v111, 7282, v111
  v_lshrrev_b32 v111, 16, v111
  v_mad_u32_u24 v111, v111, s85, v4
  v_add_u32 v112, 128, v1
  v_mul_u32_u24 v112, 7282, v112
  v_lshrrev_b32 v112, 16, v112
  v_mad_u32_u24 v112, v112, s85, v4
  v_add_u32 v113, 192, v1
  v_mul_u32_u24 v113, 7282, v113
  v_lshrrev_b32 v113, 16, v113
  v_mad_u32_u24 v113, v113, s85, v4
  v_add_u32 v114, 256, v1
  v_mul_u32_u24 v114, 7282, v114
  v_lshrrev_b32 v114, 16, v114
  v_mad_u32_u24 v114, v114, s85, v4
  v_add_u32 v115, 320, v1
  v_mul_u32_u24 v115, 7282, v115
  v_lshrrev_b32 v115, 16, v115
  v_mad_u32_u24 v115, v115, s85, v4
  v_add_u32 v116, 384, v1
  v_mul_u32_u24 v116, 7282, v116
  v_lshrrev_b32 v116, 16, v116
  v_mad_u32_u24 v116, v116, s85, v4
  v_add_u32 v117, 448, v1
  v_mul_u32_u24 v117, 7282, v117
  v_lshrrev_b32 v117, 16, v117
  v_mad_u32_u24 v117, v117, s85, v4
  v_add_u32 v118, 512, v1
  v_mul_u32_u24 v118, 7282, v118
  v_lshrrev_b32 v118, 16, v118
  v_mad_u32_u24 v118, v118, s85, v4
  s_lshl_b32 s90, s62, 2
  s_lshr_b32 s91, s63, 3
  s_add_u32 s90, s90, s91
  s_and_b32 s91, s63, 7
  s_mul_i32 s84, s90, 73728
  s_mul_i32 s85, s91, 144
  s_add_u32 s84, s84, s85
  s_add_u32 m0, s64, 10368
  s_mov_b64 s[48:49], s[16:17]
  s_mov_b32 s50, 2359296
  s_mov_b32 s51, 0x20000
  buffer_load_dwordx4 v110, s[48:51], s84 offen offset:0  lds
  buffer_load_dwordx4 v111, s[48:51], s84 offen offset:1024  lds
  buffer_load_dwordx4 v112, s[48:51], s84 offen offset:2048  lds
  buffer_load_dwordx4 v113, s[48:51], s84 offen offset:3072  lds
  s_add_u32 m0, m0, 4096
  s_add_u32 s84, s84, 4096
  buffer_load_dwordx4 v114, s[48:51], s84 offen offset:0  lds
  buffer_load_dwordx4 v115, s[48:51], s84 offen offset:1024  lds
  buffer_load_dwordx4 v116, s[48:51], s84 offen offset:2048  lds
  buffer_load_dwordx4 v117, s[48:51], s84 offen offset:3072  lds
  s_add_u32 m0, m0, 4096
  s_add_u32 s84, s84, 4096
  buffer_load_dwordx4 v118, s[48:51], s84 offen offset:0  lds
  s_waitcnt lgkmcnt(0)
  s_mul_i32 s60, s60, 1664525
  s_add_u32 s60, s60, 1013904223
  s_barrier
  s_setprio 3
  s_mov_b32 s82, s90
  s_mov_b32 s83, s91
  v_bfe_u32 v5, v1, 2, 2
  v_lshl_add_u32 v5, v3, 3, v5
  v_mul_u32_u24 v5, 144, v5
  v_and_b32 v6, 3, v1
  v_lshl_add_u32 v5, v6, 3, v5
  v_add_u32 v5, s64, v5
  v_mul_u32_u24 v6, 144, v2
  v_lshl_add_u32 v6, v3, 4, v6
  v_add_u32 v6, s64, v6
  v_lshrrev_b32 v8, 3, v1
  v_and_b32 v9, 7, v1
  v_lshlrev_b32 v9, 4, v9
  v_mul_u32_u24 v7, 144, v8
  v_add3_u32 v7, v7, v9, s64
  v_lshl_add_u32 v8, v8, 12, v9
  s_mul_i32 s84, s83, 294912
  s_lshl_b32 s85, s82, 7
  s_add_u32 s84, s84, s85
  s_add_u32 s84, s84, 3145728
  s_lshl_b32 s83, s83, 12
  s_lshl_b32 s82, s82, 7
  s_add_u32 s83, s83, s82
  s_add_u32 s83, s83, 12353536
  s_waitcnt vmcnt(0)
  ds_read_b64_tr_b16 v[64:65], v5 offset:10368
  ds_read_b64_tr_b16 v[66:67], v5 offset:10944
  ds_read_b64_tr_b16 v[68:69], v5 offset:14976
  ds_read_b64_tr_b16 v[70:71], v5 offset:15552
  ds_read_b64_tr_b16 v[72:73], v5 offset:10400
  ds_read_b64_tr_b16 v[74:75], v5 offset:10976
  ds_read_b64_tr_b16 v[76:77], v5 offset:15008
  ds_read_b64_tr_b16 v[78:79], v5 offset:15584
  ds_read_b64_tr_b16 v[80:81], v5 offset:10432
  ds_read_b64_tr_b16 v[82:83], v5 offset:11008
  ds_read_b64_tr_b16 v[84:85], v5 offset:15040
  ds_read_b64_tr_b16 v[86:87], v5 offset:15616
  ds_read_b64_tr_b16 v[88:89], v5 offset:10464
  ds_read_b64_tr_b16 v[90:91], v5 offset:11040
  ds_read_b64_tr_b16 v[92:93], v5 offset:15072
  ds_read_b64_tr_b16 v[94:95], v5 offset:15648
  ds_read_b64_tr_b16 v[96:97], v5 offset:10496
  ds_read_b64_tr_b16 v[98:99], v5 offset:11072
  ds_read_b64_tr_b16 v[100:101], v5 offset:15104
  ds_read_b64_tr_b16 v[102:103], v5 offset:15680
  s_waitcnt lgkmcnt(15)
  ds_write_b128 v6, v[64:67] offset:0
  ds_write_b128 v6, v[68:71] offset:64
  s_waitcnt lgkmcnt(15)
  ds_write_b128 v6, v[72:75] offset:2304
  s_waitcnt lgkmcnt(15)
  ds_write_b128 v6, v[76:79] offset:2368
  s_waitcnt lgkmcnt(14)
  ds_write_b128 v6, v[80:83] offset:4608
  s_waitcnt lgkmcnt(13)
  ds_write_b128 v6, v[84:87] offset:4672
  s_waitcnt lgkmcnt(12)
  ds_write_b128 v6, v[88:91] offset:6912
  s_waitcnt lgkmcnt(11)
  ds_write_b128 v6, v[92:95] offset:6976
  s_mov_b32 exec_lo, 0x00ff00ff
  s_mov_b32 exec_hi, 0x00ff00ff
  s_waitcnt lgkmcnt(10)
  ds_write_b128 v6, v[96:99] offset:9216
  s_waitcnt lgkmcnt(9)
  ds_write_b128 v6, v[100:103] offset:9280
  s_mov_b64 exec, -1
  ds_read_b128 v[64:67], v7 offset:0
  ds_read_b128 v[68:71], v7 offset:1152
  ds_read_b128 v[72:75], v7 offset:2304
  ds_read_b128 v[76:79], v7 offset:3456
  ds_read_b128 v[80:83], v7 offset:4608
  ds_read_b128 v[84:87], v7 offset:5760
  ds_read_b128 v[88:91], v7 offset:6912
  ds_read_b128 v[92:95], v7 offset:8064
  ds_read_b128 v[96:99], v7 offset:9216
  s_waitcnt lgkmcnt(8)
  buffer_store_dwordx4 v[64:67], v8, s[44:47], s84 offen sc1
  s_add_u32 s84, s84, 32768
  s_waitcnt lgkmcnt(7)
  buffer_store_dwordx4 v[68:71], v8, s[44:47], s84 offen sc1
  s_add_u32 s84, s84, 32768
  s_waitcnt lgkmcnt(6)
  buffer_store_dwordx4 v[72:75], v8, s[44:47], s84 offen sc1
  s_add_u32 s84, s84, 32768
  s_waitcnt lgkmcnt(5)
  buffer_store_dwordx4 v[76:79], v8, s[44:47], s84 offen sc1
  s_add_u32 s84, s84, 32768
  s_waitcnt lgkmcnt(4)
  buffer_store_dwordx4 v[80:83], v8, s[44:47], s84 offen sc1
  s_add_u32 s84, s84, 32768
  s_waitcnt lgkmcnt(3)
  buffer_store_dwordx4 v[84:87], v8, s[44:47], s84 offen sc1
  s_add_u32 s84, s84, 32768
  s_waitcnt lgkmcnt(2)
  buffer_store_dwordx4 v[88:91], v8, s[44:47], s84 offen sc1
  s_add_u32 s84, s84, 32768
  s_waitcnt lgkmcnt(1)
  buffer_store_dwordx4 v[92:95], v8, s[44:47], s84 offen sc1
  s_add_u32 s84, s84, 32768
  s_waitcnt lgkmcnt(0)
  buffer_store_dwordx4 v[96:99], v8, s[44:47], s84 offen sc1
  v_lshlrev_b32 v5, 3, v3
  s_mov_b32 s84, 0x8001
  s_movk_i32 s85, 0x3f80
  v_mov_b32 v6, 0x3800
  v_lshlrev_b32 v6, v2, v6
  v_lshrrev_b32 v6, v5, v6
  v_bfe_u32 v40, v6, 0, 2
  v_mul_u32_u24 v40, s84, v40
  v_and_b32 v40, 0x10001, v40
  v_mul_u32_u24 v40, s85, v40
  v_bfe_u32 v41, v6, 2, 2
  v_mul_u32_u24 v41, s84, v41
  v_and_b32 v41, 0x10001, v41
  v_mul_u32_u24 v41, s85, v41
  v_bfe_u32 v42, v6, 4, 2
  v_mul_u32_u24 v42, s84, v42
  v_and_b32 v42, 0x10001, v42
  v_mul_u32_u24 v42, s85, v42
  v_bfe_u32 v43, v6, 6, 2
  v_mul_u32_u24 v43, s84, v43
  v_and_b32 v43, 0x10001, v43
  v_mul_u32_u24 v43, s85, v43
  v_mov_b32 v6, 0x7c0
  v_lshlrev_b32 v6, v2, v6
  v_lshrrev_b32 v6, v5, v6
  v_bfe_u32 v44, v6, 0, 2
  v_mul_u32_u24 v44, s84, v44
  v_and_b32 v44, 0x10001, v44
  v_mul_u32_u24 v44, s85, v44
  v_bfe_u32 v45, v6, 2, 2
  v_mul_u32_u24 v45, s84, v45
  v_and_b32 v45, 0x10001, v45
  v_mul_u32_u24 v45, s85, v45
  v_bfe_u32 v46, v6, 4, 2
  v_mul_u32_u24 v46, s84, v46
  v_and_b32 v46, 0x10001, v46
  v_mul_u32_u24 v46, s85, v46
  v_bfe_u32 v47, v6, 6, 2
  v_mul_u32_u24 v47, s84, v47
  v_and_b32 v47, 0x10001, v47
  v_mul_u32_u24 v47, s85, v47
  v_mov_b32 v6, 0x38
  v_lshlrev_b32 v6, v2, v6
  v_lshrrev_b32 v6, v5, v6
  v_bfe_u32 v48, v6, 0, 2
  v_mul_u32_u24 v48, s84, v48
  v_and_b32 v48, 0x10001, v48
  v_mul_u32_u24 v48, s85, v48
  v_bfe_u32 v49, v6, 2, 2
  v_mul_u32_u24 v49, s84, v49
  v_and_b32 v49, 0x10001, v49
  v_mul_u32_u24 v49, s85, v49
  v_bfe_u32 v50, v6, 4, 2
  v_mul_u32_u24 v50, s84, v50
  v_and_b32 v50, 0x10001, v50
  v_mul_u32_u24 v50, s85, v50
  v_bfe_u32 v51, v6, 6, 2
  v_mul_u32_u24 v51, s84, v51
  v_and_b32 v51, 0x10001, v51
  v_mul_u32_u24 v51, s85, v51
  v_mov_b32 v6, 0x7c0
  v_lshlrev_b32 v6, v2, v6
  v_lshrrev_b32 v6, v5, v6
  v_bfe_u32 v52, v6, 0, 2
  v_mul_u32_u24 v52, s84, v52
  v_and_b32 v52, 0x10001, v52
  v_mul_u32_u24 v52, s85, v52
  v_bfe_u32 v53, v6, 2, 2
  v_mul_u32_u24 v53, s84, v53
  v_and_b32 v53, 0x10001, v53
  v_mul_u32_u24 v53, s85, v53
  v_bfe_u32 v54, v6, 4, 2
  v_mul_u32_u24 v54, s84, v54
  v_and_b32 v54, 0x10001, v54
  v_mul_u32_u24 v54, s85, v54
  v_bfe_u32 v55, v6, 6, 2
  v_mul_u32_u24 v55, s84, v55
  v_and_b32 v55, 0x10001, v55
  v_mul_u32_u24 v55, s85, v55
  v_mov_b32 v6, 0xfe0
  v_lshlrev_b32 v6, v2, v6
  v_lshrrev_b32 v6, v5, v6
  v_bfe_u32 v56, v6, 0, 2
  v_mul_u32_u24 v56, s84, v56
  v_and_b32 v56, 0x10001, v56
  v_mul_u32_u24 v56, s85, v56
  v_bfe_u32 v57, v6, 2, 2
  v_mul_u32_u24 v57, s84, v57
  v_and_b32 v57, 0x10001, v57
  v_mul_u32_u24 v57, s85, v57
  v_bfe_u32 v58, v6, 4, 2
  v_mul_u32_u24 v58, s84, v58
  v_and_b32 v58, 0x10001, v58
  v_mul_u32_u24 v58, s85, v58
  v_bfe_u32 v59, v6, 6, 2
  v_mul_u32_u24 v59, s84, v59
  v_and_b32 v59, 0x10001, v59
  v_mul_u32_u24 v59, s85, v59
  v_mov_b32 v6, 0x1ff0
  v_lshlrev_b32 v6, v2, v6
  v_lshrrev_b32 v6, v5, v6
  v_bfe_u32 v60, v6, 0, 2
  v_mul_u32_u24 v60, s84, v60
  v_and_b32 v60, 0x10001, v60
  v_mul_u32_u24 v60, s85, v60
  v_bfe_u32 v61, v6, 2, 2
  v_mul_u32_u24 v61, s84, v61
  v_and_b32 v61, 0x10001, v61
  v_mul_u32_u24 v61, s85, v61
  v_bfe_u32 v62, v6, 4, 2
  v_mul_u32_u24 v62, s84, v62
  v_and_b32 v62, 0x10001, v62
  v_mul_u32_u24 v62, s85, v62
  v_bfe_u32 v63, v6, 6, 2
  v_mul_u32_u24 v63, s84, v63
  v_and_b32 v63, 0x10001, v63
  v_mul_u32_u24 v63, s85, v63
  v_add_u32 v5, 75776, v4
  ds_write_b128 v5, v[40:43] offset:0
  ds_write_b128 v5, v[44:47] offset:1024
  ds_write_b128 v5, v[48:51] offset:2048
  ds_write_b128 v5, v[52:55] offset:3072
  ds_write_b128 v5, v[56:59] offset:4096
  ds_write_b128 v5, v[60:63] offset:5120
  v_mov_b32 v6, s60
  s_waitcnt vmcnt(0)
  s_mov_b64 exec, 1
  buffer_store_dword v6, v4, s[44:47], s83 offen sc1
  s_mov_b64 exec, -1
  v_and_b32 v5, 31, v1
  v_lshlrev_b32 v5, 7, v5
  s_lshl_b32 s82, s62, 12
  s_add_u32 s82, s82, 12353536
  s_and_b32 s83, s63, 3
  s_lshl_b32 s83, s83, 1
  s_add_u32 s83, s83, s89
  s_lshl_b32 s83, s83, 12
  s_add_u32 s83, s83, 3145728
  s_add_u32 s84, s83, 4096
  s_lshl_b32 s85, s86, 12
  s_add_u32 s85, s85, 3145728
  s_waitcnt vmcnt(0) lgkmcnt(0)
  s_movk_i32 s65, 3000
Lpoll_11:
  buffer_load_dword v6, v5, s[44:47], s82 offen sc1
  s_sub_u32 s65, s65, 1
  s_cbranch_scc1 Lpolld_12x
  s_waitcnt vmcnt(0)
  v_cmp_ne_u32 vcc, s60, v6
  s_nop 0
  s_cbranch_vccz Lpolld_12
  s_sleep 4
  s_branch Lpoll_11
Lpolld_12x:
  s_waitcnt vmcnt(0)
Lpolld_12:
  s_mov_b32 m0, 6144
  s_nop 0
  buffer_load_dwordx4 v4, s[44:47], s83 offen offset:0 sc1 lds
  buffer_load_dwordx4 v4, s[44:47], s83 offen offset:1024 sc1 lds
  buffer_load_dwordx4 v4, s[44:47], s83 offen offset:2048 sc1 lds
  buffer_load_dwordx4 v4, s[44:47], s83 offen offset:3072 sc1 lds
  s_mov_b32 m0, 16384
  s_nop 0
  buffer_load_dwordx4 v4, s[44:47], s84 offen offset:0 sc1 lds
  buffer_load_dwordx4 v4, s[44:47], s84 offen offset:1024 sc1 lds
  buffer_load_dwordx4 v4, s[44:47], s84 offen offset:2048 sc1 lds
  buffer_load_dwordx4 v4, s[44:47], s84 offen offset:3072 sc1 lds
  s_mov_b32 m0, 26624
  s_nop 0
  buffer_load_dwordx4 v4, s[44:47], s85 offen offset:0 sc1 lds
  buffer_load_dwordx4 v4, s[44:47], s85 offen offset:1024 sc1 lds
  buffer_load_dwordx4 v4, s[44:47], s85 offen offset:2048 sc1 lds
  buffer_load_dwordx4 v4, s[44:47], s85 offen offset:3072 sc1 lds
  v_min_u32 v5, 35, v1
  v_lshlrev_b32 v5, 7, v5
  s_and_b32 s82, s63, 3
  s_lshl_b32 s82, s82, 13
  s_add_u32 s82, s82, 12320768
  buffer_load_dword v6, v5, s[44:47], s82 offen sc1
  s_waitcnt vmcnt(0)
  v_cmp_ne_u32 vcc, s60, v6
  s_nop 0
  s_cbranch_vccz Lwo_14
  s_waitcnt vmcnt(0) lgkmcnt(0)
  s_movk_i32 s65, 3000
Lpoll_15:
  buffer_load_dword v6, v5, s[44:47], s82 offen sc1
  s_sub_u32 s65, s65, 1
  s_cbranch_scc1 Lpolld_16x
  s_waitcnt vmcnt(0)
  v_cmp_ne_u32 vcc, s60, v6
  s_nop 0
  s_cbranch_vccz Lpolld_16
  s_sleep 4
  s_branch Lpoll_15
Lpolld_16x:
  s_waitcnt vmcnt(0)
Lpolld_16:
Lwo_14:
  s_setprio 0
L_Aconv:
  s_and_b32 s70, s61, 1
  s_mul_i32 s71, s70, 10240
  s_and_b32 s72, s63, 3
  s_lshl_b32 s73, s72, 1
  s_add_u32 s73, s73, s70
  s_add_u32 s73, s73, s89
  s_lshl_b32 s74, s73, 12
  s_add_u32 s74, s74, 5505024
  s_lshl_b32 s64, s61, 11
  s_add_u32 s64, s64, 30720
  v_and_b32 v5, 1, v2
  v_lshlrev_b32 v6, 1, v2
  v_sub_u32 v6, s71, v6
  v_mul_u32_u24 v7, 1346, v5
  v_lshl_add_u32 v7, v3, 4, v7
  v_add3_u32 v244, v7, v6, 36
  v_add_u32 v245, 512, v244
  v_mul_u32_u24 v7, 962, v5
  v_lshl_add_u32 v7, v3, 3, v7
  v_add_u32 v7, v7, v6
  v_add_u32 v246, 2688, v7
  v_lshlrev_b32 v7, 5, v2
  v_lshl_add_u32 v248, v3, 4, v7
  v_add_u32 v247, s71, v248
  v_add_u32 v249, 75776, v4
  s_and_b32 s9, s63, 3
  s_mul_i32 s9, s9, 165888
  s_add_u32 s9, s9, 2228224
  s_mul_i32 s10, s61, 36864
  s_add_u32 s10, s9, s10
  v_add_u32 v252, 18432, v4
  s_add_u32 s11, s61, 0
  s_and_b32 s11, s11, 3
  s_lshl_b32 s11, s11, 12
  s_add_u32 s11, s11, s10
  s_add_u32 s12, s61, 1
  s_and_b32 s12, s12, 3
  s_lshl_b32 s12, s12, 12
  s_add_u32 s12, s12, s10
  s_add_u32 s13, s61, 2
  s_and_b32 s13, s13, 3
  s_lshl_b32 s13, s13, 12
  s_add_u32 s13, s13, s10
  s_add_u32 s14, s61, 3
  s_and_b32 s14, s14, 3
  s_lshl_b32 s14, s14, 12
  s_add_u32 s14, s14, s10
  s_add_u32 s15, s10, 16384
  s_lshl_b32 s92, s61, 12
  s_add_u32 s93, s9, 147456
  s_add_u32 s94, s93, s92
  s_add_u32 s92, s92, 40960
  s_and_b32 s95, s61, 1
  s_lshl_b32 s95, s95, 10
  s_add_u32 s93, s93, s95
  s_add_u32 s93, s93, 16384
  s_add_u32 s95, s95, 57344
  s_barrier
  s_setprio 0
  s_cmp_ge_u32 s61, 2
  s_cbranch_scc1 L_Alight
  ds_read2_b32 v[168:169], v245 offset0:152 offset1:153
  ds_read2_b32 v[170:171], v245 offset0:154 offset1:155
  ds_read_b128 v[184:187], v247 offset:9696
  ds_read_b128 v[188:191], v247 offset:9184
  ds_read_b128 v[192:195], v247 offset:8672
  ds_read_b128 v[196:199], v247 offset:8160
  ds_read_b128 v[200:203], v247 offset:7648
  ds_read2_b32 v[172:173], v244 offset0:152 offset1:153
  ds_read2_b32 v[174:175], v244 offset0:154 offset1:155
  s_waitcnt lgkmcnt(0)
  v_mfma_f32_16x16x32_bf16 v[152:155], v[168:171], v[196:199], 0
  ds_read2_b32 v[176:177], v245 offset0:136 offset1:137
  ds_read2_b32 v[178:179], v245 offset0:138 offset1:139
  v_mfma_f32_16x16x32_bf16 v[156:159], v[168:171], v[192:195], 0
  ds_read_b128 v[204:207], v247 offset:9632
  ds_read_b128 v[208:211], v247 offset:9120
  v_mfma_f32_16x16x32_bf16 v[160:163], v[168:171], v[188:191], 0
  ds_read_b128 v[212:215], v247 offset:8608
  ds_read_b128 v[216:219], v247 offset:8096
  v_mfma_f32_16x16x32_bf16 v[164:167], v[168:171], v[184:187], 0
  ds_read_b128 v[220:223], v247 offset:7584
  ds_read2_b32 v[180:181], v244 offset0:136 offset1:137
  v_mfma_f32_16x16x32_bf16 v[152:155], v[172:175], v[200:203], v[152:155]
  ds_read2_b32 v[182:183], v244 offset0:138 offset1:139
  buffer_load_dwordx4 v[8:11], v4, s[44:47], s11 offen offset:0 sc1
  v_mfma_f32_16x16x32_bf16 v[156:159], v[172:175], v[196:199], v[156:159]
  buffer_load_dwordx4 v[12:15], v4, s[44:47], s11 offen offset:1024 sc1
  buffer_load_dwordx4 v[16:19], v4, s[44:47], s11 offen offset:2048 sc1
  v_mfma_f32_16x16x32_bf16 v[160:163], v[172:175], v[192:195], v[160:163]
  buffer_load_dwordx4 v[20:23], v4, s[44:47], s11 offen offset:3072 sc1
  buffer_load_dwordx4 v[80:83], v252, s[44:47], s11 offen offset:0 sc1
  v_mfma_f32_16x16x32_bf16 v[164:167], v[172:175], v[188:191], v[164:167]
  s_waitcnt lgkmcnt(0)
  v_mfma_f32_16x16x32_bf16 v[152:155], v[176:179], v[216:219], v[152:155]
  ds_read2_b32 v[168:169], v244 offset0:248 offset1:249
  ds_read2_b32 v[170:171], v244 offset0:250 offset1:251
  v_mfma_f32_16x16x32_bf16 v[156:159], v[176:179], v[212:215], v[156:159]
  ds_read_b128 v[184:187], v247 offset:9568
  ds_read_b128 v[188:191], v247 offset:9056
  v_mfma_f32_16x16x32_bf16 v[160:163], v[176:179], v[208:211], v[160:163]
  ds_read_b128 v[192:195], v247 offset:8544
  ds_read_b128 v[196:199], v247 offset:8032
  v_mfma_f32_16x16x32_bf16 v[164:167], v[176:179], v[204:207], v[164:167]
  ds_read_b128 v[200:203], v247 offset:7520
  ds_read2_b32 v[172:173], v244 offset0:120 offset1:121
  v_mfma_f32_16x16x32_bf16 v[152:155], v[180:183], v[220:223], v[152:155]
  ds_read2_b32 v[174:175], v244 offset0:122 offset1:123
  buffer_load_dwordx4 v[84:87], v252, s[44:47], s11 offen offset:1024 sc1
  v_mfma_f32_16x16x32_bf16 v[156:159], v[180:183], v[216:219], v[156:159]
  buffer_load_dwordx4 v[88:91], v252, s[44:47], s11 offen offset:2048 sc1
  buffer_load_dwordx4 v[92:95], v252, s[44:47], s11 offen offset:3072 sc1
  v_mfma_f32_16x16x32_bf16 v[160:163], v[180:183], v[212:215], v[160:163]
  buffer_load_dwordx4 v[24:27], v4, s[44:47], s12 offen offset:0 sc1
  buffer_load_dwordx4 v[28:31], v4, s[44:47], s12 offen offset:1024 sc1
  v_mfma_f32_16x16x32_bf16 v[164:167], v[180:183], v[208:211], v[164:167]
  s_waitcnt lgkmcnt(0)
  v_mfma_f32_16x16x32_bf16 v[152:155], v[168:171], v[196:199], v[152:155]
  ds_read2_b32 v[176:177], v244 offset0:232 offset1:233
  ds_read2_b32 v[178:179], v244 offset0:234 offset1:235
  v_mfma_f32_16x16x32_bf16 v[156:159], v[168:171], v[192:195], v[156:159]
  ds_read_b128 v[204:207], v247 offset:9504
  ds_read_b128 v[208:211], v247 offset:8992
  v_mfma_f32_16x16x32_bf16 v[160:163], v[168:171], v[188:191], v[160:163]
  ds_read_b128 v[212:215], v247 offset:8480
  ds_read_b128 v[216:219], v247 offset:7968
  v_mfma_f32_16x16x32_bf16 v[164:167], v[168:171], v[184:187], v[164:167]
  ds_read_b128 v[220:223], v247 offset:7456
  ds_read2_b32 v[180:181], v244 offset0:104 offset1:105
  v_mfma_f32_16x16x32_bf16 v[152:155], v[172:175], v[200:203], v[152:155]
  ds_read2_b32 v[182:183], v244 offset0:106 offset1:107
  buffer_load_dwordx4 v[32:35], v4, s[44:47], s12 offen offset:2048 sc1
  v_mfma_f32_16x16x32_bf16 v[156:159], v[172:175], v[196:199], v[156:159]
  buffer_load_dwordx4 v[36:39], v4, s[44:47], s12 offen offset:3072 sc1
  buffer_load_dwordx4 v[96:99], v252, s[44:47], s12 offen offset:0 sc1
  v_mfma_f32_16x16x32_bf16 v[160:163], v[172:175], v[192:195], v[160:163]
  buffer_load_dwordx4 v[100:103], v252, s[44:47], s12 offen offset:1024 sc1
  buffer_load_dwordx4 v[104:107], v252, s[44:47], s12 offen offset:2048 sc1
  v_mfma_f32_16x16x32_bf16 v[164:167], v[172:175], v[188:191], v[164:167]
  s_waitcnt lgkmcnt(0)
  v_mfma_f32_16x16x32_bf16 v[152:155], v[176:179], v[216:219], v[152:155]
  ds_read2_b32 v[168:169], v244 offset0:216 offset1:217
  ds_read2_b32 v[170:171], v244 offset0:218 offset1:219
  v_mfma_f32_16x16x32_bf16 v[156:159], v[176:179], v[212:215], v[156:159]
  ds_read_b128 v[184:187], v247 offset:9440
  ds_read_b128 v[188:191], v247 offset:8928
  v_mfma_f32_16x16x32_bf16 v[160:163], v[176:179], v[208:211], v[160:163]
  ds_read_b128 v[192:195], v247 offset:8416
  ds_read_b128 v[196:199], v247 offset:7904
  v_mfma_f32_16x16x32_bf16 v[164:167], v[176:179], v[204:207], v[164:167]
  ds_read_b128 v[200:203], v247 offset:7392
  ds_read2_b32 v[172:173], v244 offset0:88 offset1:89
  v_mfma_f32_16x16x32_bf16 v[152:155], v[180:183], v[220:223], v[152:155]
  ds_read2_b32 v[174:175], v244 offset0:90 offset1:91
  buffer_load_dwordx4 v[108:111], v252, s[44:47], s12 offen offset:3072 sc1
  v_mfma_f32_16x16x32_bf16 v[156:159], v[180:183], v[216:219], v[156:159]
  buffer_load_dwordx4 v[40:43], v4, s[44:47], s13 offen offset:0 sc1
  buffer_load_dwordx4 v[44:47], v4, s[44:47], s13 offen offset:1024 sc1
  v_mfma_f32_16x16x32_bf16 v[160:163], v[180:183], v[212:215], v[160:163]
  buffer_load_dwordx4 v[48:51], v4, s[44:47], s13 offen offset:2048 sc1
  buffer_load_dwordx4 v[52:55], v4, s[44:47], s13 offen offset:3072 sc1
  v_mfma_f32_16x16x32_bf16 v[164:167], v[180:183], v[208:211], v[164:167]
  s_waitcnt lgkmcnt(0)
  v_mfma_f32_16x16x32_bf16 v[152:155], v[168:171], v[196:199], v[152:155]
  ds_read2_b32 v[176:177], v244 offset0:200 offset1:201
  ds_read2_b32 v[178:179], v244 offset0:202 offset1:203
  v_mfma_f32_16x16x32_bf16 v[156:159], v[168:171], v[192:195], v[156:159]
  ds_read_b128 v[204:207], v247 offset:9376
  ds_read_b128 v[208:211], v247 offset:8864
  v_mfma_f32_16x16x32_bf16 v[160:163], v[168:171], v[188:191], v[160:163]
  ds_read_b128 v[212:215], v247 offset:8352
  ds_read_b128 v[216:219], v247 offset:7840
  v_mfma_f32_16x16x32_bf16 v[164:167], v[168:171], v[184:187], v[164:167]
  ds_read_b128 v[220:223], v247 offset:7328
  ds_read2_b32 v[180:181], v244 offset0:72 offset1:73
  v_mfma_f32_16x16x32_bf16 v[152:155], v[172:175], v[200:203], v[152:155]
  ds_read2_b32 v[182:183], v244 offset0:74 offset1:75
  buffer_load_dwordx4 v[112:115], v252, s[44:47], s13 offen offset:0 sc1
  v_mfma_f32_16x16x32_bf16 v[156:159], v[172:175], v[196:199], v[156:159]
  buffer_load_dwordx4 v[116:119], v252, s[44:47], s13 offen offset:1024 sc1
  buffer_load_dwordx4 v[120:123], v252, s[44:47], s13 offen offset:2048 sc1
  v_mfma_f32_16x16x32_bf16 v[160:163], v[172:175], v[192:195], v[160:163]
  buffer_load_dwordx4 v[124:127], v252, s[44:47], s13 offen offset:3072 sc1
  buffer_load_dwordx4 v[56:59], v4, s[44:47], s14 offen offset:0 sc1
  v_mfma_f32_16x16x32_bf16 v[164:167], v[172:175], v[188:191], v[164:167]
  s_waitcnt lgkmcnt(0)
  v_mfma_f32_16x16x32_bf16 v[152:155], v[176:179], v[216:219], v[152:155]
  ds_read2_b32 v[168:169], v244 offset0:184 offset1:185
  ds_read2_b32 v[170:171], v244 offset0:186 offset1:187
  v_mfma_f32_16x16x32_bf16 v[156:159], v[176:179], v[212:215], v[156:159]
  ds_read_b128 v[184:187], v247 offset:9312
  ds_read_b128 v[188:191], v247 offset:8800
  v_mfma_f32_16x16x32_bf16 v[160:163], v[176:179], v[208:211], v[160:163]
  ds_read_b128 v[192:195], v247 offset:8288
  ds_read_b128 v[196:199], v247 offset:7776
  v_mfma_f32_16x16x32_bf16 v[164:167], v[176:179], v[204:207], v[164:167]
  ds_read_b128 v[200:203], v247 offset:7264
  ds_read2_b32 v[172:173], v244 offset0:56 offset1:57
  v_mfma_f32_16x16x32_bf16 v[152:155], v[180:183], v[220:223], v[152:155]
  ds_read2_b32 v[174:175], v244 offset0:58 offset1:59
  buffer_load_dwordx4 v[60:63], v4, s[44:47], s14 offen offset:1024 sc1
  v_mfma_f32_16x16x32_bf16 v[156:159], v[180:183], v[216:219], v[156:159]
  buffer_load_dwordx4 v[64:67], v4, s[44:47], s14 offen offset:2048 sc1
  buffer_load_dwordx4 v[68:71], v4, s[44:47], s14 offen offset:3072 sc1
  v_mfma_f32_16x16x32_bf16 v[160:163], v[180:183], v[212:215], v[160:163]
  buffer_load_dwordx4 v[128:131], v252, s[44:47], s14 offen offset:0 sc1
  buffer_load_dwordx4 v[132:135], v252, s[44:47], s14 offen offset:1024 sc1
  v_mfma_f32_16x16x32_bf16 v[164:167], v[180:183], v[208:211], v[164:167]
  s_waitcnt lgkmcnt(0)
  v_mfma_f32_16x16x32_bf16 v[152:155], v[168:171], v[196:199], v[152:155]
  ds_read2_b32 v[176:177], v244 offset0:168 offset1:169
  ds_read2_b32 v[178:179], v244 offset0:170 offset1:171
  v_mfma_f32_16x16x32_bf16 v[156:159], v[168:171], v[192:195], v[156:159]
  ds_read_b128 v[204:207], v247 offset:9248
  ds_read_b128 v[208:211], v247 offset:8736
  v_mfma_f32_16x16x32_bf16 v[160:163], v[168:171], v[188:191], v[160:163]
  ds_read_b128 v[212:215], v247 offset:8224
  ds_read_b128 v[216:219], v247 offset:7712
  v_mfma_f32_16x16x32_bf16 v[164:167], v[168:171], v[184:187], v[164:167]
  ds_read_b128 v[220:223], v247 offset:7200
  ds_read2_b32 v[180:181], v244 offset0:40 offset1:41
  v_mfma_f32_16x16x32_bf16 v[152:155], v[172:175], v[200:203], v[152:155]
  ds_read2_b32 v[182:183], v244 offset0:42 offset1:43
  buffer_load_dwordx4 v[136:139], v252, s[44:47], s14 offen offset:2048 sc1
  v_mfma_f32_16x16x32_bf16 v[156:159], v[172:175], v[196:199], v[156:159]
  buffer_load_dwordx4 v[140:143], v252, s[44:47], s14 offen offset:3072 sc1
  buffer_load_dwordx4 v[72:75], v4, s[44:47], s15 offen offset:0 sc1
  v_mfma_f32_16x16x32_bf16 v[160:163], v[172:175], v[192:195], v[160:163]
  buffer_load_dwordx4 v[76:79], v4, s[44:47], s15 offen offset:1024 sc1
  buffer_load_dwordx4 v[144:147], v252, s[44:47], s15 offen offset:0 sc1
  v_mfma_f32_16x16x32_bf16 v[164:167], v[172:175], v[188:191], v[164:167]
  s_waitcnt lgkmcnt(0)
  v_mfma_f32_16x16x32_bf16 v[152:155], v[176:179], v[216:219], v[152:155]
  buffer_load_dwordx4 v[148:151], v252, s[44:47], s15 offen offset:1024 sc1
  s_mov_b32 m0, s92
  s_nop 0
  buffer_load_dwordx4 v4, s[44:47], s94 offen sc1 lds
  v_mfma_f32_16x16x32_bf16 v[156:159], v[176:179], v[212:215], v[156:159]
  buffer_load_dwordx4 v4, s[44:47], s94 offen offset:1024 sc1 lds
  buffer_load_dwordx4 v4, s[44:47], s94 offen offset:2048 sc1 lds
  v_mfma_f32_16x16x32_bf16 v[160:163], v[176:179], v[208:211], v[160:163]
  buffer_load_dwordx4 v4, s[44:47], s94 offen offset:3072 sc1 lds
  v_mfma_f32_16x16x32_bf16 v[164:167], v[176:179], v[204:207], v[164:167]
  v_mfma_f32_16x16x32_bf16 v[152:155], v[180:183], v[220:223], v[152:155]
  v_mfma_f32_16x16x32_bf16 v[156:159], v[180:183], v[216:219], v[156:159]
  v_mfma_f32_16x16x32_bf16 v[160:163], v[180:183], v[212:215], v[160:163]
  v_mfma_f32_16x16x32_bf16 v[164:167], v[180:183], v[208:211], v[164:167]
  ds_read_b128 v[168:171], v249 offset:0
  ds_read_b128 v[172:175], v249 offset:1024
  ds_read_b128 v[196:199], v247 offset:6112
  ds_read_b128 v[204:207], v247 offset:6624
  ds_read2_b32 v[188:189], v244 offset0:24 offset1:25
  ds_read2_b32 v[190:191], v244 offset0:26 offset1:27
  ds_read2_b32 v[192:193], v244 offset0:0 offset1:1
  ds_read2_b32 v[194:195], v244 offset0:2 offset1:3
  s_waitcnt lgkmcnt(5)
  v_mfma_f32_16x16x32_bf16 v[220:223], v[196:199], v[168:171], 0
  ds_read2_b32 v[176:177], v246 offset0:24 offset1:25
  ds_read2_b32 v[178:179], v246 offset0:60 offset1:61
  v_mfma_f32_16x16x32_bf16 v[224:227], v[196:199], v[172:175], 0
  ds_read2_b32 v[180:181], v246 offset0:16 offset1:17
  ds_read2_b32 v[182:183], v246 offset0:52 offset1:53
  s_waitcnt lgkmcnt(4)
  v_mfma_f32_16x16x32_bf16 v[152:155], v[192:195], v[196:199], v[152:155]
  ds_read2_b32 v[184:185], v246 offset0:8 offset1:9
  ds_read2_b32 v[186:187], v246 offset0:44 offset1:45
  ds_read_b128 v[212:215], v247 offset:7136
  s_mov_b32 m0, s95
  s_nop 0
  buffer_load_dwordx4 v4, s[44:47], s93 offen sc1 lds
  v_mfma_f32_16x16x32_bf16 v[228:231], v[204:207], v[168:171], 0
  ds_read_b128 v[196:199], v247 offset:7648
  v_cvt_pk_bf16_f32 v220, v220, v221
  v_mfma_f32_16x16x32_bf16 v[232:235], v[204:207], v[172:175], 0
  v_cvt_pk_bf16_f32 v221, v222, v223
  v_cvt_pk_bf16_f32 v222, v224, v225
  v_mfma_f32_16x16x32_bf16 v[156:159], v[192:195], v[204:207], v[156:159]
  v_cvt_pk_bf16_f32 v223, v226, v227
  s_waitcnt lgkmcnt(1)
  v_mfma_f32_16x16x32_bf16 v[236:239], v[212:215], v[168:171], 0
  ds_read_b128 v[204:207], v247 offset:8160
  v_cvt_pk_bf16_f32 v228, v228, v229
  v_mfma_f32_16x16x32_bf16 v[240:243], v[212:215], v[172:175], 0
  v_cvt_pk_bf16_f32 v229, v230, v231
  v_cvt_pk_bf16_f32 v230, v232, v233
  v_mfma_f32_16x16x32_bf16 v[152:155], v[188:191], v[212:215], v[152:155]
  v_cvt_pk_bf16_f32 v231, v234, v235
  v_mfma_f32_16x16x32_bf16 v[160:163], v[192:195], v[212:215], v[160:163]
  v_mfma_f32_16x16x32_bf16 v[152:155], v[220:223], v[184:187], v[152:155]
  s_waitcnt lgkmcnt(1)
  v_mfma_f32_16x16x32_bf16 v[220:223], v[196:199], v[168:171], 0
  ds_read_b128 v[212:215], v247 offset:8672
  v_cvt_pk_bf16_f32 v236, v236, v237
  v_mfma_f32_16x16x32_bf16 v[224:227], v[196:199], v[172:175], 0
  v_cvt_pk_bf16_f32 v237, v238, v239
  v_cvt_pk_bf16_f32 v238, v240, v241
  v_mfma_f32_16x16x32_bf16 v[156:159], v[188:191], v[196:199], v[156:159]
  v_cvt_pk_bf16_f32 v239, v242, v243
  v_mfma_f32_16x16x32_bf16 v[164:167], v[192:195], v[196:199], v[164:167]
  v_mfma_f32_16x16x32_bf16 v[152:155], v[228:231], v[180:183], v[152:155]
  v_mfma_f32_16x16x32_bf16 v[156:159], v[228:231], v[184:187], v[156:159]
  s_waitcnt lgkmcnt(1)
  v_mfma_f32_16x16x32_bf16 v[228:231], v[204:207], v[168:171], 0
  v_cvt_pk_bf16_f32 v220, v220, v221
  v_cvt_pk_bf16_f32 v221, v222, v223
  v_mfma_f32_16x16x32_bf16 v[232:235], v[204:207], v[172:175], 0
  v_cvt_pk_bf16_f32 v222, v224, v225
  v_cvt_pk_bf16_f32 v223, v226, v227
  v_mfma_f32_16x16x32_bf16 v[160:163], v[188:191], v[204:207], v[160:163]
  v_mfma_f32_16x16x32_bf16 v[152:155], v[236:239], v[176:179], v[152:155]
  v_mfma_f32_16x16x32_bf16 v[156:159], v[236:239], v[180:183], v[156:159]
  v_mfma_f32_16x16x32_bf16 v[160:163], v[236:239], v[184:187], v[160:163]
  s_waitcnt lgkmcnt(0)
  v_mfma_f32_16x16x32_bf16 v[236:239], v[212:215], v[168:171], 0
  v_cvt_pk_bf16_f32 v228, v228, v229
  v_cvt_pk_bf16_f32 v229, v230, v231
  v_mfma_f32_16x16x32_bf16 v[240:243], v[212:215], v[172:175], 0
  v_cvt_pk_bf16_f32 v230, v232, v233
  v_cvt_pk_bf16_f32 v231, v234, v235
  v_mfma_f32_16x16x32_bf16 v[164:167], v[188:191], v[212:215], v[164:167]
  v_mfma_f32_16x16x32_bf16 v[156:159], v[220:223], v[176:179], v[156:159]
  v_mfma_f32_16x16x32_bf16 v[160:163], v[220:223], v[180:183], v[160:163]
  v_mfma_f32_16x16x32_bf16 v[164:167], v[220:223], v[184:187], v[164:167]
  v_mfma_f32_16x16x32_bf16 v[160:163], v[228:231], v[176:179], v[160:163]
  v_cvt_pk_bf16_f32 v236, v236, v237
  v_cvt_pk_bf16_f32 v237, v238, v239
  v_mfma_f32_16x16x32_bf16 v[164:167], v[228:231], v[180:183], v[164:167]
  v_cvt_pk_bf16_f32 v238, v240, v241
  v_cvt_pk_bf16_f32 v239, v242, v243
  s_nop 1
  v_mfma_f32_16x16x32_bf16 v[164:167], v[236:239], v[176:179], v[164:167]
  ds_read_b128 v[168:171], v249 offset:2048
  ds_read_b128 v[172:175], v249 offset:3072
  ds_read_b128 v[196:199], v247 offset:6112
  ds_read_b128 v[200:203], v247 offset:6096
  ds_read_b128 v[204:207], v247 offset:6624
  ds_read_b128 v[208:211], v247 offset:6608
  s_waitcnt lgkmcnt(3)
  v_mfma_f32_16x16x32_bf16 v[220:223], v[196:199], v[168:171], 0
  ds_read2_b32 v[176:177], v246 offset0:96 offset1:97
  ds_read2_b32 v[178:179], v246 offset0:132 offset1:133
  s_waitcnt lgkmcnt(4)
  v_mfma_f32_16x16x32_bf16 v[224:227], v[200:203], v[172:175], 0
  ds_read2_b32 v[180:181], v246 offset0:88 offset1:89
  ds_read2_b32 v[182:183], v246 offset0:124 offset1:125
  ds_read2_b32 v[184:185], v246 offset0:80 offset1:81
  ds_read2_b32 v[186:187], v246 offset0:116 offset1:117
  ds_read_b128 v[212:215], v247 offset:7136
  ds_read_b128 v[216:219], v247 offset:7120
  s_waitcnt lgkmcnt(9)
  v_mfma_f32_16x16x32_bf16 v[228:231], v[204:207], v[168:171], 0
  ds_read_b128 v[196:199], v247 offset:7648
  ds_read_b128 v[200:203], v247 offset:7632
  s_waitcnt lgkmcnt(10)
  v_mfma_f32_16x16x32_bf16 v[232:235], v[208:211], v[172:175], 0
  v_cvt_pk_bf16_f32 v220, v220, v221
  v_cvt_pk_bf16_f32 v221, v222, v223
  v_cvt_pk_bf16_f32 v222, v224, v225
  v_cvt_pk_bf16_f32 v223, v226, v227
  s_waitcnt lgkmcnt(3)
  v_mfma_f32_16x16x32_bf16 v[236:239], v[212:215], v[168:171], 0
  ds_read_b128 v[204:207], v247 offset:8160
  ds_read_b128 v[208:211], v247 offset:8144
  s_waitcnt lgkmcnt(4)
  v_mfma_f32_16x16x32_bf16 v[240:243], v[216:219], v[172:175], 0
  v_cvt_pk_bf16_f32 v228, v228, v229
  v_cvt_pk_bf16_f32 v229, v230, v231
  v_mfma_f32_16x16x32_bf16 v[152:155], v[220:223], v[184:187], v[152:155]
  v_cvt_pk_bf16_f32 v230, v232, v233
  v_cvt_pk_bf16_f32 v231, v234, v235
  s_waitcnt lgkmcnt(3)
  v_mfma_f32_16x16x32_bf16 v[220:223], v[196:199], v[168:171], 0
  ds_read_b128 v[212:215], v247 offset:8672
  ds_read_b128 v[216:219], v247 offset:8656
  s_waitcnt lgkmcnt(4)
  v_mfma_f32_16x16x32_bf16 v[224:227], v[200:203], v[172:175], 0
  v_cvt_pk_bf16_f32 v236, v236, v237
  v_cvt_pk_bf16_f32 v237, v238, v239
  v_mfma_f32_16x16x32_bf16 v[152:155], v[228:231], v[180:183], v[152:155]
  v_cvt_pk_bf16_f32 v238, v240, v241
  v_cvt_pk_bf16_f32 v239, v242, v243
  v_mfma_f32_16x16x32_bf16 v[156:159], v[228:231], v[184:187], v[156:159]
  s_waitcnt lgkmcnt(3)
  v_mfma_f32_16x16x32_bf16 v[228:231], v[204:207], v[168:171], 0
  v_cvt_pk_bf16_f32 v220, v220, v221
  v_cvt_pk_bf16_f32 v221, v222, v223
  s_waitcnt lgkmcnt(2)
  v_mfma_f32_16x16x32_bf16 v[232:235], v[208:211], v[172:175], 0
  v_cvt_pk_bf16_f32 v222, v224, v225
  v_cvt_pk_bf16_f32 v223, v226, v227
  v_mfma_f32_16x16x32_bf16 v[152:155], v[236:239], v[176:179], v[152:155]
  v_mfma_f32_16x16x32_bf16 v[156:159], v[236:239], v[180:183], v[156:159]
  v_mfma_f32_16x16x32_bf16 v[160:163], v[236:239], v[184:187], v[160:163]
  s_waitcnt lgkmcnt(1)
  v_mfma_f32_16x16x32_bf16 v[236:239], v[212:215], v[168:171], 0
  v_cvt_pk_bf16_f32 v228, v228, v229
  v_cvt_pk_bf16_f32 v229, v230, v231
  s_waitcnt lgkmcnt(0)
  v_mfma_f32_16x16x32_bf16 v[240:243], v[216:219], v[172:175], 0
  v_cvt_pk_bf16_f32 v230, v232, v233
  v_cvt_pk_bf16_f32 v231, v234, v235
  v_mfma_f32_16x16x32_bf16 v[156:159], v[220:223], v[176:179], v[156:159]
  v_mfma_f32_16x16x32_bf16 v[160:163], v[220:223], v[180:183], v[160:163]
  v_mfma_f32_16x16x32_bf16 v[164:167], v[220:223], v[184:187], v[164:167]
  v_mfma_f32_16x16x32_bf16 v[160:163], v[228:231], v[176:179], v[160:163]
  v_cvt_pk_bf16_f32 v236, v236, v237
  v_cvt_pk_bf16_f32 v237, v238, v239
  v_mfma_f32_16x16x32_bf16 v[164:167], v[228:231], v[180:183], v[164:167]
  v_cvt_pk_bf16_f32 v238, v240, v241
  v_cvt_pk_bf16_f32 v239, v242, v243
  s_nop 1
  v_mfma_f32_16x16x32_bf16 v[164:167], v[236:239], v[176:179], v[164:167]
  ds_read_b128 v[168:171], v249 offset:4096
  ds_read_b128 v[172:175], v249 offset:5120
  ds_read_b128 v[196:199], v247 offset:6112
  ds_read_b128 v[200:203], v247 offset:6096
  ds_read_b128 v[204:207], v247 offset:6624
  ds_read_b128 v[208:211], v247 offset:6608
  s_waitcnt lgkmcnt(3)
  v_mfma_f32_16x16x32_bf16 v[220:223], v[196:199], v[168:171], 0
  ds_read2_b32 v[176:177], v246 offset0:180 offset1:181
  ds_read2_b32 v[178:179], v246 offset0:228 offset1:229
  s_waitcnt lgkmcnt(4)
  v_mfma_f32_16x16x32_bf16 v[224:227], v[200:203], v[172:175], 0
  ds_read2_b32 v[180:181], v246 offset0:172 offset1:173
  ds_read2_b32 v[182:183], v246 offset0:220 offset1:221
  ds_read2_b32 v[184:185], v246 offset0:164 offset1:165
  ds_read2_b32 v[186:187], v246 offset0:212 offset1:213
  ds_read2_b32 v[188:189], v246 offset0:156 offset1:157
  ds_read2_b32 v[190:191], v246 offset0:204 offset1:205
  ds_read_b128 v[212:215], v247 offset:7136
  ds_read_b128 v[216:219], v247 offset:7120
  s_waitcnt lgkmcnt(11)
  v_mfma_f32_16x16x32_bf16 v[228:231], v[204:207], v[168:171], 0
  ds_read_b128 v[196:199], v247 offset:7648
  ds_read_b128 v[200:203], v247 offset:7632
  s_waitcnt lgkmcnt(12)
  v_mfma_f32_16x16x32_bf16 v[232:235], v[208:211], v[172:175], 0
  v_cvt_pk_bf16_f32 v220, v220, v221
  v_cvt_pk_bf16_f32 v221, v222, v223
  v_cvt_pk_bf16_f32 v222, v224, v225
  v_cvt_pk_bf16_f32 v223, v226, v227
  s_waitcnt lgkmcnt(3)
  v_mfma_f32_16x16x32_bf16 v[236:239], v[212:215], v[168:171], 0
  v_cvt_pk_bf16_f32 v228, v228, v229
  v_cvt_pk_bf16_f32 v229, v230, v231
  s_waitcnt lgkmcnt(2)
  v_mfma_f32_16x16x32_bf16 v[240:243], v[216:219], v[172:175], 0
  v_cvt_pk_bf16_f32 v230, v232, v233
  v_cvt_pk_bf16_f32 v231, v234, v235
  v_mfma_f32_16x16x32_bf16 v[152:155], v[220:223], v[176:179], v[152:155]
  v_mfma_f32_16x16x32_bf16 v[156:159], v[220:223], v[180:183], v[156:159]
  v_mfma_f32_16x16x32_bf16 v[160:163], v[220:223], v[184:187], v[160:163]
  v_mfma_f32_16x16x32_bf16 v[164:167], v[220:223], v[188:191], v[164:167]
  s_waitcnt lgkmcnt(1)
  v_mfma_f32_16x16x32_bf16 v[220:223], v[196:199], v[168:171], 0
  v_cvt_pk_bf16_f32 v236, v236, v237
  v_cvt_pk_bf16_f32 v237, v238, v239
  s_waitcnt lgkmcnt(0)
  v_mfma_f32_16x16x32_bf16 v[224:227], v[200:203], v[172:175], 0
  v_cvt_pk_bf16_f32 v238, v240, v241
  v_cvt_pk_bf16_f32 v239, v242, v243
  v_mfma_f32_16x16x32_bf16 v[156:159], v[228:231], v[176:179], v[156:159]
  v_mfma_f32_16x16x32_bf16 v[160:163], v[228:231], v[180:183], v[160:163]
  v_mfma_f32_16x16x32_bf16 v[164:167], v[228:231], v[184:187], v[164:167]
  v_mfma_f32_16x16x32_bf16 v[160:163], v[236:239], v[176:179], v[160:163]
  v_cvt_pk_bf16_f32 v220, v220, v221
  v_cvt_pk_bf16_f32 v221, v222, v223
  v_mfma_f32_16x16x32_bf16 v[164:167], v[236:239], v[180:183], v[164:167]
  v_cvt_pk_bf16_f32 v222, v224, v225
  v_cvt_pk_bf16_f32 v223, v226, v227
  s_nop 1
  v_mfma_f32_16x16x32_bf16 v[164:167], v[220:223], v[176:179], v[164:167]
  s_add_u32 s74, s74, 2048
  v_lshlrev_b32 v5, 5, v2
  v_lshl_add_u32 v5, v3, 3, v5
  v_add_u32 v5, s64, v5
  v_add_u32 v6, s64, v4
  v_cvt_pk_bf16_f32 v168, v152, v153
  v_cvt_pk_bf16_f32 v169, v154, v155
  v_cvt_pk_bf16_f32 v170, v156, v157
  v_cvt_pk_bf16_f32 v171, v158, v159
  v_cvt_pk_bf16_f32 v172, v160, v161
  v_cvt_pk_bf16_f32 v173, v162, v163
  v_cvt_pk_bf16_f32 v174, v164, v165
  v_cvt_pk_bf16_f32 v175, v166, v167
  ds_write2_b64 v5, v[168:169], v[170:171] offset0:0 offset1:64
  ds_write2_b64 v5, v[172:173], v[174:175] offset0:128 offset1:192
  ds_read_b128 v[160:163], v6
  ds_read_b128 v[164:167], v6 offset:1024
  s_waitcnt lgkmcnt(1)
  buffer_store_dwordx4 v[160:163], v4, s[44:47], s74 offen sc1
  s_waitcnt lgkmcnt(0)
  buffer_store_dwordx4 v[164:167], v4, s[44:47], s74 offen offset:1024 sc1
  s_branch L_Afinal
L_Alight:
  ds_read2_b32 v[168:169], v245 offset0:152 offset1:153
  ds_read2_b32 v[170:171], v245 offset0:154 offset1:155
  ds_read_b128 v[184:187], v247 offset:7648
  ds_read_b128 v[188:191], v247 offset:7136
  ds_read_b128 v[192:195], v247 offset:6624
  ds_read_b128 v[196:199], v247 offset:6112
  ds_read2_b32 v[172:173], v244 offset0:152 offset1:153
  ds_read2_b32 v[174:175], v244 offset0:154 offset1:155
  s_waitcnt lgkmcnt(0)
  v_mfma_f32_16x16x32_bf16 v[152:155], v[168:171], v[196:199], 0
  ds_read2_b32 v[176:177], v245 offset0:136 offset1:137
  ds_read2_b32 v[178:179], v245 offset0:138 offset1:139
  v_mfma_f32_16x16x32_bf16 v[156:159], v[168:171], v[192:195], 0
  ds_read_b128 v[204:207], v247 offset:7584
  ds_read_b128 v[208:211], v247 offset:7072
  v_mfma_f32_16x16x32_bf16 v[160:163], v[168:171], v[188:191], 0
  ds_read_b128 v[212:215], v247 offset:6560
  ds_read_b128 v[216:219], v247 offset:6048
  v_mfma_f32_16x16x32_bf16 v[164:167], v[168:171], v[184:187], 0
  ds_read2_b32 v[180:181], v244 offset0:136 offset1:137
  ds_read2_b32 v[182:183], v244 offset0:138 offset1:139
  v_mfma_f32_16x16x32_bf16 v[156:159], v[172:175], v[196:199], v[156:159]
  buffer_load_dwordx4 v[8:11], v4, s[44:47], s11 offen offset:0 sc1
  buffer_load_dwordx4 v[12:15], v4, s[44:47], s11 offen offset:1024 sc1
  v_mfma_f32_16x16x32_bf16 v[160:163], v[172:175], v[192:195], v[160:163]
  buffer_load_dwordx4 v[16:19], v4, s[44:47], s11 offen offset:2048 sc1
  buffer_load_dwordx4 v[20:23], v4, s[44:47], s11 offen offset:3072 sc1
  v_mfma_f32_16x16x32_bf16 v[164:167], v[172:175], v[188:191], v[164:167]
  buffer_load_dwordx4 v[80:83], v252, s[44:47], s11 offen offset:0 sc1
  s_waitcnt lgkmcnt(0)
  v_mfma_f32_16x16x32_bf16 v[152:155], v[176:179], v[216:219], v[152:155]
  ds_read2_b32 v[168:169], v244 offset0:248 offset1:249
  ds_read2_b32 v[170:171], v244 offset0:250 offset1:251
  v_mfma_f32_16x16x32_bf16 v[156:159], v[176:179], v[212:215], v[156:159]
  ds_read_b128 v[184:187], v247 offset:7520
  ds_read_b128 v[188:191], v247 offset:7008
  v_mfma_f32_16x16x32_bf16 v[160:163], v[176:179], v[208:211], v[160:163]
  ds_read_b128 v[192:195], v247 offset:6496
  ds_read_b128 v[196:199], v247 offset:5984
  v_mfma_f32_16x16x32_bf16 v[164:167], v[176:179], v[204:207], v[164:167]
  ds_read2_b32 v[172:173], v244 offset0:120 offset1:121
  ds_read2_b32 v[174:175], v244 offset0:122 offset1:123
  v_mfma_f32_16x16x32_bf16 v[156:159], v[180:183], v[216:219], v[156:159]
  buffer_load_dwordx4 v[84:87], v252, s[44:47], s11 offen offset:1024 sc1
  buffer_load_dwordx4 v[88:91], v252, s[44:47], s11 offen offset:2048 sc1
  v_mfma_f32_16x16x32_bf16 v[160:163], v[180:183], v[212:215], v[160:163]
  buffer_load_dwordx4 v[92:95], v252, s[44:47], s11 offen offset:3072 sc1
  buffer_load_dwordx4 v[24:27], v4, s[44:47], s12 offen offset:0 sc1
  v_mfma_f32_16x16x32_bf16 v[164:167], v[180:183], v[208:211], v[164:167]
  buffer_load_dwordx4 v[28:31], v4, s[44:47], s12 offen offset:1024 sc1
  s_waitcnt lgkmcnt(0)
  v_mfma_f32_16x16x32_bf16 v[152:155], v[168:171], v[196:199], v[152:155]
  ds_read2_b32 v[176:177], v244 offset0:232 offset1:233
  ds_read2_b32 v[178:179], v244 offset0:234 offset1:235
  v_mfma_f32_16x16x32_bf16 v[156:159], v[168:171], v[192:195], v[156:159]
  ds_read_b128 v[204:207], v247 offset:7456
  ds_read_b128 v[208:211], v247 offset:6944
  v_mfma_f32_16x16x32_bf16 v[160:163], v[168:171], v[188:191], v[160:163]
  ds_read_b128 v[212:215], v247 offset:6432
  ds_read_b128 v[216:219], v247 offset:5920
  v_mfma_f32_16x16x32_bf16 v[164:167], v[168:171], v[184:187], v[164:167]
  ds_read2_b32 v[180:181], v244 offset0:104 offset1:105
  ds_read2_b32 v[182:183], v244 offset0:106 offset1:107
  v_mfma_f32_16x16x32_bf16 v[156:159], v[172:175], v[196:199], v[156:159]
  buffer_load_dwordx4 v[32:35], v4, s[44:47], s12 offen offset:2048 sc1
  buffer_load_dwordx4 v[36:39], v4, s[44:47], s12 offen offset:3072 sc1
  v_mfma_f32_16x16x32_bf16 v[160:163], v[172:175], v[192:195], v[160:163]
  buffer_load_dwordx4 v[96:99], v252, s[44:47], s12 offen offset:0 sc1
  buffer_load_dwordx4 v[100:103], v252, s[44:47], s12 offen offset:1024 sc1
  v_mfma_f32_16x16x32_bf16 v[164:167], v[172:175], v[188:191], v[164:167]
  buffer_load_dwordx4 v[104:107], v252, s[44:47], s12 offen offset:2048 sc1
  s_waitcnt lgkmcnt(0)
  v_mfma_f32_16x16x32_bf16 v[152:155], v[176:179], v[216:219], v[152:155]
  ds_read2_b32 v[168:169], v244 offset0:216 offset1:217
  ds_read2_b32 v[170:171], v244 offset0:218 offset1:219
  v_mfma_f32_16x16x32_bf16 v[156:159], v[176:179], v[212:215], v[156:159]
  ds_read_b128 v[184:187], v247 offset:7392
  ds_read_b128 v[188:191], v247 offset:6880
  v_mfma_f32_16x16x32_bf16 v[160:163], v[176:179], v[208:211], v[160:163]
  ds_read_b128 v[192:195], v247 offset:6368
  ds_read_b128 v[196:199], v247 offset:5856
  v_mfma_f32_16x16x32_bf16 v[164:167], v[176:179], v[204:207], v[164:167]
  ds_read2_b32 v[172:173], v244 offset0:88 offset1:89
  ds_read2_b32 v[174:175], v244 offset0:90 offset1:91
  v_mfma_f32_16x16x32_bf16 v[156:159], v[180:183], v[216:219], v[156:159]
  buffer_load_dwordx4 v[108:111], v252, s[44:47], s12 offen offset:3072 sc1
  buffer_load_dwordx4 v[40:43], v4, s[44:47], s13 offen offset:0 sc1
  v_mfma_f32_16x16x32_bf16 v[160:163], v[180:183], v[212:215], v[160:163]
  buffer_load_dwordx4 v[44:47], v4, s[44:47], s13 offen offset:1024 sc1
  buffer_load_dwordx4 v[48:51], v4, s[44:47], s13 offen offset:2048 sc1
  v_mfma_f32_16x16x32_bf16 v[164:167], v[180:183], v[208:211], v[164:167]
  buffer_load_dwordx4 v[52:55], v4, s[44:47], s13 offen offset:3072 sc1
  s_waitcnt lgkmcnt(0)
  v_mfma_f32_16x16x32_bf16 v[152:155], v[168:171], v[196:199], v[152:155]
  ds_read2_b32 v[176:177], v244 offset0:200 offset1:201
  ds_read2_b32 v[178:179], v244 offset0:202 offset1:203
  v_mfma_f32_16x16x32_bf16 v[156:159], v[168:171], v[192:195], v[156:159]
  ds_read_b128 v[204:207], v247 offset:7328
  ds_read_b128 v[208:211], v247 offset:6816
  v_mfma_f32_16x16x32_bf16 v[160:163], v[168:171], v[188:191], v[160:163]
  ds_read_b128 v[212:215], v247 offset:6304
  ds_read_b128 v[216:219], v247 offset:5792
  v_mfma_f32_16x16x32_bf16 v[164:167], v[168:171], v[184:187], v[164:167]
  ds_read2_b32 v[180:181], v244 offset0:72 offset1:73
  ds_read2_b32 v[182:183], v244 offset0:74 offset1:75
  v_mfma_f32_16x16x32_bf16 v[156:159], v[172:175], v[196:199], v[156:159]
  buffer_load_dwordx4 v[112:115], v252, s[44:47], s13 offen offset:0 sc1
  buffer_load_dwordx4 v[116:119], v252, s[44:47], s13 offen offset:1024 sc1
  v_mfma_f32_16x16x32_bf16 v[160:163], v[172:175], v[192:195], v[160:163]
  buffer_load_dwordx4 v[120:123], v252, s[44:47], s13 offen offset:2048 sc1
  buffer_load_dwordx4 v[124:127], v252, s[44:47], s13 offen offset:3072 sc1
  v_mfma_f32_16x16x32_bf16 v[164:167], v[172:175], v[188:191], v[164:167]
  buffer_load_dwordx4 v[56:59], v4, s[44:47], s14 offen offset:0 sc1
  s_waitcnt lgkmcnt(0)
  v_mfma_f32_16x16x32_bf16 v[152:155], v[176:179], v[216:219], v[152:155]
  ds_read2_b32 v[168:169], v244 offset0:184 offset1:185
  ds_read2_b32 v[170:171], v244 offset0:186 offset1:187
  v_mfma_f32_16x16x32_bf16 v[156:159], v[176:179], v[212:215], v[156:159]
  ds_read_b128 v[184:187], v247 offset:7264
  ds_read_b128 v[188:191], v247 offset:6752
  v_mfma_f32_16x16x32_bf16 v[160:163], v[176:179], v[208:211], v[160:163]
  ds_read_b128 v[192:195], v247 offset:6240
  ds_read_b128 v[196:199], v247 offset:5728
  v_mfma_f32_16x16x32_bf16 v[164:167], v[176:179], v[204:207], v[164:167]
  ds_read2_b32 v[172:173], v244 offset0:56 offset1:57
  ds_read2_b32 v[174:175], v244 offset0:58 offset1:59
  v_mfma_f32_16x16x32_bf16 v[156:159], v[180:183], v[216:219], v[156:159]
  buffer_load_dwordx4 v[60:63], v4, s[44:47], s14 offen offset:1024 sc1
  buffer_load_dwordx4 v[64:67], v4, s[44:47], s14 offen offset:2048 sc1
  v_mfma_f32_16x16x32_bf16 v[160:163], v[180:183], v[212:215], v[160:163]
  buffer_load_dwordx4 v[68:71], v4, s[44:47], s14 offen offset:3072 sc1
  buffer_load_dwordx4 v[128:131], v252, s[44:47], s14 offen offset:0 sc1
  v_mfma_f32_16x16x32_bf16 v[164:167], v[180:183], v[208:211], v[164:167]
  buffer_load_dwordx4 v[132:135], v252, s[44:47], s14 offen offset:1024 sc1
  s_waitcnt lgkmcnt(0)
  v_mfma_f32_16x16x32_bf16 v[152:155], v[168:171], v[196:199], v[152:155]
  ds_read2_b32 v[176:177], v244 offset0:168 offset1:169
  ds_read2_b32 v[178:179], v244 offset0:170 offset1:171
  v_mfma_f32_16x16x32_bf16 v[156:159], v[168:171], v[192:195], v[156:159]
  ds_read_b128 v[204:207], v247 offset:7200
  ds_read_b128 v[208:211], v247 offset:6688
  v_mfma_f32_16x16x32_bf16 v[160:163], v[168:171], v[188:191], v[160:163]
  ds_read_b128 v[212:215], v247 offset:6176
  ds_read_b128 v[216:219], v247 offset:5664
  v_mfma_f32_16x16x32_bf16 v[164:167], v[168:171], v[184:187], v[164:167]
  ds_read2_b32 v[180:181], v244 offset0:40 offset1:41
  ds_read2_b32 v[182:183], v244 offset0:42 offset1:43
  v_mfma_f32_16x16x32_bf16 v[156:159], v[172:175], v[196:199], v[156:159]
  buffer_load_dwordx4 v[136:139], v252, s[44:47], s14 offen offset:2048 sc1
  buffer_load_dwordx4 v[140:143], v252, s[44:47], s14 offen offset:3072 sc1
  v_mfma_f32_16x16x32_bf16 v[160:163], v[172:175], v[192:195], v[160:163]
  buffer_load_dwordx4 v[72:75], v4, s[44:47], s15 offen offset:0 sc1
  buffer_load_dwordx4 v[76:79], v4, s[44:47], s15 offen offset:1024 sc1
  v_mfma_f32_16x16x32_bf16 v[164:167], v[172:175], v[188:191], v[164:167]
  buffer_load_dwordx4 v[144:147], v252, s[44:47], s15 offen offset:0 sc1
  s_waitcnt lgkmcnt(0)
  v_mfma_f32_16x16x32_bf16 v[152:155], v[176:179], v[216:219], v[152:155]
  buffer_load_dwordx4 v[148:151], v252, s[44:47], s15 offen offset:1024 sc1
  s_mov_b32 m0, s92
  s_nop 0
  buffer_load_dwordx4 v4, s[44:47], s94 offen sc1 lds
  v_mfma_f32_16x16x32_bf16 v[156:159], v[176:179], v[212:215], v[156:159]
  buffer_load_dwordx4 v4, s[44:47], s94 offen offset:1024 sc1 lds
  buffer_load_dwordx4 v4, s[44:47], s94 offen offset:2048 sc1 lds
  v_mfma_f32_16x16x32_bf16 v[160:163], v[176:179], v[208:211], v[160:163]
  buffer_load_dwordx4 v4, s[44:47], s94 offen offset:3072 sc1 lds
  v_mfma_f32_16x16x32_bf16 v[164:167], v[176:179], v[204:207], v[164:167]
  v_mfma_f32_16x16x32_bf16 v[156:159], v[180:183], v[216:219], v[156:159]
  v_mfma_f32_16x16x32_bf16 v[160:163], v[180:183], v[212:215], v[160:163]
  v_mfma_f32_16x16x32_bf16 v[164:167], v[180:183], v[208:211], v[164:167]
  ds_read_b128 v[168:171], v249 offset:0
  ds_read_b128 v[172:175], v249 offset:1024
  ds_read_b128 v[196:199], v247 offset:6112
  ds_read_b128 v[204:207], v247 offset:6624
  ds_read2_b32 v[188:189], v244 offset0:24 offset1:25
  ds_read2_b32 v[190:191], v244 offset0:26 offset1:27
  s_waitcnt lgkmcnt(3)
  v_mfma_f32_16x16x32_bf16 v[220:223], v[196:199], v[168:171], 0
  ds_read2_b32 v[176:177], v246 offset0:24 offset1:25
  ds_read2_b32 v[178:179], v246 offset0:60 offset1:61
  v_mfma_f32_16x16x32_bf16 v[224:227], v[196:199], v[172:175], 0
  ds_read2_b32 v[180:181], v246 offset0:16 offset1:17
  ds_read2_b32 v[182:183], v246 offset0:52 offset1:53
  s_waitcnt lgkmcnt(4)
  v_mfma_f32_16x16x32_bf16 v[160:163], v[188:191], v[196:199], v[160:163]
  s_mov_b32 m0, s95
  s_nop 0
  buffer_load_dwordx4 v4, s[44:47], s93 offen sc1 lds
  v_mfma_f32_16x16x32_bf16 v[228:231], v[204:207], v[168:171], 0
  v_cvt_pk_bf16_f32 v220, v220, v221
  v_cvt_pk_bf16_f32 v221, v222, v223
  v_mfma_f32_16x16x32_bf16 v[232:235], v[204:207], v[172:175], 0
  v_cvt_pk_bf16_f32 v222, v224, v225
  v_cvt_pk_bf16_f32 v223, v226, v227
  v_mfma_f32_16x16x32_bf16 v[164:167], v[188:191], v[204:207], v[164:167]
  s_waitcnt lgkmcnt(2)
  v_mfma_f32_16x16x32_bf16 v[160:163], v[220:223], v[176:179], v[160:163]
  v_cvt_pk_bf16_f32 v228, v228, v229
  v_cvt_pk_bf16_f32 v229, v230, v231
  s_waitcnt lgkmcnt(0)
  v_mfma_f32_16x16x32_bf16 v[164:167], v[220:223], v[180:183], v[164:167]
  v_cvt_pk_bf16_f32 v230, v232, v233
  v_cvt_pk_bf16_f32 v231, v234, v235
  s_nop 1
  v_mfma_f32_16x16x32_bf16 v[164:167], v[228:231], v[176:179], v[164:167]
  ds_read_b128 v[168:171], v249 offset:2048
  ds_read_b128 v[172:175], v249 offset:3072
  ds_read_b128 v[196:199], v247 offset:6112
  ds_read_b128 v[200:203], v247 offset:6096
  ds_read_b128 v[204:207], v247 offset:6624
  ds_read_b128 v[208:211], v247 offset:6608
  s_waitcnt lgkmcnt(3)
  v_mfma_f32_16x16x32_bf16 v[220:223], v[196:199], v[168:171], 0
  ds_read2_b32 v[176:177], v246 offset0:96 offset1:97
  ds_read2_b32 v[178:179], v246 offset0:132 offset1:133
  s_waitcnt lgkmcnt(4)
  v_mfma_f32_16x16x32_bf16 v[224:227], v[200:203], v[172:175], 0
  ds_read2_b32 v[180:181], v246 offset0:88 offset1:89
  ds_read2_b32 v[182:183], v246 offset0:124 offset1:125
  s_waitcnt lgkmcnt(5)
  v_mfma_f32_16x16x32_bf16 v[228:231], v[204:207], v[168:171], 0
  v_cvt_pk_bf16_f32 v220, v220, v221
  v_cvt_pk_bf16_f32 v221, v222, v223
  s_waitcnt lgkmcnt(4)
  v_mfma_f32_16x16x32_bf16 v[232:235], v[208:211], v[172:175], 0
  v_cvt_pk_bf16_f32 v222, v224, v225
  v_cvt_pk_bf16_f32 v223, v226, v227
  s_waitcnt lgkmcnt(2)
  s_nop 0
  v_mfma_f32_16x16x32_bf16 v[160:163], v[220:223], v[176:179], v[160:163]
  v_cvt_pk_bf16_f32 v228, v228, v229
  v_cvt_pk_bf16_f32 v229, v230, v231
  s_waitcnt lgkmcnt(0)
  v_mfma_f32_16x16x32_bf16 v[164:167], v[220:223], v[180:183], v[164:167]
  v_cvt_pk_bf16_f32 v230, v232, v233
  v_cvt_pk_bf16_f32 v231, v234, v235
  s_nop 1
  v_mfma_f32_16x16x32_bf16 v[164:167], v[228:231], v[176:179], v[164:167]
  v_lshlrev_b32 v5, 5, v2
  v_lshl_add_u32 v5, v3, 3, v5
  v_add_u32 v5, s64, v5
  v_add_u32 v6, s64, v4
  v_cvt_pk_bf16_f32 v168, v152, v153
  v_cvt_pk_bf16_f32 v169, v154, v155
  v_cvt_pk_bf16_f32 v170, v156, v157
  v_cvt_pk_bf16_f32 v171, v158, v159
  v_cvt_pk_bf16_f32 v172, v160, v161
  v_cvt_pk_bf16_f32 v173, v162, v163
  v_cvt_pk_bf16_f32 v174, v164, v165
  v_cvt_pk_bf16_f32 v175, v166, v167
  ds_write2_b64 v5, v[168:169], v[170:171] offset0:0 offset1:64
  ds_write2_b64 v5, v[172:173], v[174:175] offset0:128 offset1:192
  ds_read_b128 v[160:163], v6
  ds_read_b128 v[164:167], v6 offset:1024
  s_waitcnt lgkmcnt(1)
  buffer_store_dwordx4 v[160:163], v4, s[44:47], s74 offen sc1
  s_waitcnt lgkmcnt(0)
  buffer_store_dwordx4 v[164:167], v4, s[44:47], s74 offen offset:1024 sc1
  s_sub_u32 s78, 7, s72
  s_cmp_eq_u32 s70, 0
  s_cselect_b32 s78, s72, s78
  s_movk_i32 s71, 20480
  v_and_b32 v5, 1, v2
  v_lshlrev_b32 v6, 1, v2
  v_sub_u32 v6, s71, v6
  v_mul_u32_u24 v7, 1346, v5
  v_lshl_add_u32 v7, v3, 4, v7
  v_add3_u32 v244, v7, v6, 36
  v_add_u32 v245, 512, v244
  v_mul_u32_u24 v7, 962, v5
  v_lshl_add_u32 v7, v3, 3, v7
  v_add_u32 v7, v7, v6
  v_add_u32 v246, 2688, v7
  v_lshlrev_b32 v7, 5, v2
  v_lshl_add_u32 v248, v3, 4, v7
  v_add_u32 v247, s71, v248
  v_add_u32 v249, 75776, v4
  s_lshl_b32 s76, s78, 9
  s_add_u32 s77, s76, 25568
  v_add_u32 v247, s77, v248
  s_sub_u32 s3, s76, 1024
  s_cselect_b32 s3, -1280, s3
  s_add_u32 s3, s3, 26576
  s_sub_u32 s4, s76, 1536
  s_cselect_b32 s4, -1280, s4
  s_add_u32 s4, s4, 26576
  s_sub_u32 s5, s76, 2048
  s_cselect_b32 s5, -1280, s5
  s_add_u32 s5, s5, 26576
  s_sub_u32 s6, s76, 2560
  s_cselect_b32 s6, -1280, s6
  s_add_u32 s6, s6, 26576
  s_sub_u32 s7, s76, 3072
  s_cselect_b32 s7, -1280, s7
  s_add_u32 s7, s7, 26576
  s_sub_u32 s8, s76, 3584
  s_cselect_b32 s8, -1280, s8
  s_add_u32 s8, s8, 26576
  ds_read2_b32 v[168:169], v245 offset0:152 offset1:153
  ds_read2_b32 v[170:171], v245 offset0:154 offset1:155
  ds_read_b128 v[172:175], v247 offset:1024
  ds_read2_b32 v[176:177], v245 offset0:136 offset1:137
  ds_read2_b32 v[178:179], v245 offset0:138 offset1:139
  ds_read_b128 v[180:183], v247 offset:960
  ds_read2_b32 v[184:185], v244 offset0:248 offset1:249
  ds_read2_b32 v[186:187], v244 offset0:250 offset1:251
  ds_read_b128 v[188:191], v247 offset:896
  ds_read2_b32 v[192:193], v244 offset0:232 offset1:233
  ds_read2_b32 v[194:195], v244 offset0:234 offset1:235
  ds_read_b128 v[196:199], v247 offset:832
  s_waitcnt lgkmcnt(9)
  v_mfma_f32_16x16x32_bf16 v[152:155], v[168:171], v[172:175], 0
  ds_read2_b32 v[200:201], v244 offset0:216 offset1:217
  ds_read2_b32 v[202:203], v244 offset0:218 offset1:219
  ds_read_b128 v[204:207], v247 offset:768
  s_waitcnt lgkmcnt(9)
  v_mfma_f32_16x16x32_bf16 v[156:159], v[176:179], v[180:183], 0
  ds_read2_b32 v[168:169], v244 offset0:200 offset1:201
  ds_read2_b32 v[170:171], v244 offset0:202 offset1:203
  ds_read_b128 v[172:175], v247 offset:704
  s_waitcnt lgkmcnt(9)
  v_mfma_f32_16x16x32_bf16 v[152:155], v[184:187], v[188:191], v[152:155]
  ds_read2_b32 v[176:177], v244 offset0:184 offset1:185
  ds_read2_b32 v[178:179], v244 offset0:186 offset1:187
  ds_read_b128 v[180:183], v247 offset:640
  s_waitcnt lgkmcnt(9)
  v_mfma_f32_16x16x32_bf16 v[156:159], v[192:195], v[196:199], v[156:159]
  ds_read2_b32 v[184:185], v244 offset0:168 offset1:169
  ds_read2_b32 v[186:187], v244 offset0:170 offset1:171
  ds_read_b128 v[188:191], v247 offset:576
  s_waitcnt lgkmcnt(9)
  v_mfma_f32_16x16x32_bf16 v[152:155], v[200:203], v[204:207], v[152:155]
  ds_read2_b32 v[192:193], v244 offset0:152 offset1:153
  ds_read2_b32 v[194:195], v244 offset0:154 offset1:155
  ds_read_b128 v[196:199], v247 offset:512
  s_waitcnt lgkmcnt(9)
  v_mfma_f32_16x16x32_bf16 v[156:159], v[168:171], v[172:175], v[156:159]
  ds_read2_b32 v[200:201], v244 offset0:136 offset1:137
  ds_read2_b32 v[202:203], v244 offset0:138 offset1:139
  ds_read_b128 v[204:207], v247 offset:448
  s_waitcnt lgkmcnt(9)
  v_mfma_f32_16x16x32_bf16 v[152:155], v[176:179], v[180:183], v[152:155]
  ds_read2_b32 v[168:169], v244 offset0:120 offset1:121
  ds_read2_b32 v[170:171], v244 offset0:122 offset1:123
  ds_read_b128 v[172:175], v247 offset:384
  s_waitcnt lgkmcnt(9)
  v_mfma_f32_16x16x32_bf16 v[156:159], v[184:187], v[188:191], v[156:159]
  ds_read2_b32 v[176:177], v244 offset0:104 offset1:105
  ds_read2_b32 v[178:179], v244 offset0:106 offset1:107
  ds_read_b128 v[180:183], v247 offset:320
  s_waitcnt lgkmcnt(9)
  v_mfma_f32_16x16x32_bf16 v[152:155], v[192:195], v[196:199], v[152:155]
  ds_read2_b32 v[184:185], v244 offset0:88 offset1:89
  ds_read2_b32 v[186:187], v244 offset0:90 offset1:91
  ds_read_b128 v[188:191], v247 offset:256
  s_waitcnt lgkmcnt(9)
  v_mfma_f32_16x16x32_bf16 v[156:159], v[200:203], v[204:207], v[156:159]
  ds_read2_b32 v[192:193], v244 offset0:72 offset1:73
  ds_read2_b32 v[194:195], v244 offset0:74 offset1:75
  ds_read_b128 v[196:199], v247 offset:192
  s_waitcnt lgkmcnt(9)
  v_mfma_f32_16x16x32_bf16 v[152:155], v[168:171], v[172:175], v[152:155]
  ds_read2_b32 v[200:201], v244 offset0:56 offset1:57
  ds_read2_b32 v[202:203], v244 offset0:58 offset1:59
  ds_read_b128 v[204:207], v247 offset:128
  s_waitcnt lgkmcnt(9)
  v_mfma_f32_16x16x32_bf16 v[156:159], v[176:179], v[180:183], v[156:159]
  ds_read2_b32 v[168:169], v244 offset0:40 offset1:41
  ds_read2_b32 v[170:171], v244 offset0:42 offset1:43
  ds_read_b128 v[172:175], v247 offset:64
  s_waitcnt lgkmcnt(9)
  v_mfma_f32_16x16x32_bf16 v[152:155], v[184:187], v[188:191], v[152:155]
  ds_read2_b32 v[176:177], v244 offset0:24 offset1:25
  ds_read2_b32 v[178:179], v244 offset0:26 offset1:27
  ds_read_b128 v[180:183], v247 offset:0
  s_waitcnt lgkmcnt(9)
  v_mfma_f32_16x16x32_bf16 v[156:159], v[192:195], v[196:199], v[156:159]
  s_waitcnt lgkmcnt(6)
  v_mfma_f32_16x16x32_bf16 v[152:155], v[200:203], v[204:207], v[152:155]
  s_waitcnt lgkmcnt(3)
  v_mfma_f32_16x16x32_bf16 v[156:159], v[168:171], v[172:175], v[156:159]
  s_waitcnt lgkmcnt(0)
  v_mfma_f32_16x16x32_bf16 v[152:155], v[176:179], v[180:183], v[152:155]
  ds_read_b128 v[168:171], v249 offset:0
  ds_read_b128 v[172:175], v249 offset:1024
  v_add_u32 v250, s3, v248
  ds_read_b128 v[196:199], v250 offset:16
  v_add_u32 v251, s4, v248
  ds_read_b128 v[204:207], v251 offset:16
  ds_read2_b32 v[188:189], v244 offset0:0 offset1:1
  ds_read2_b32 v[190:191], v244 offset0:2 offset1:3
  s_waitcnt lgkmcnt(3)
  v_mfma_f32_16x16x32_bf16 v[220:223], v[196:199], v[168:171], 0
  ds_read2_b32 v[176:177], v246 offset0:24 offset1:25
  ds_read2_b32 v[178:179], v246 offset0:60 offset1:61
  v_mfma_f32_16x16x32_bf16 v[224:227], v[196:199], v[172:175], 0
  ds_read2_b32 v[180:181], v246 offset0:16 offset1:17
  ds_read2_b32 v[182:183], v246 offset0:52 offset1:53
  ds_read2_b32 v[184:185], v246 offset0:8 offset1:9
  ds_read2_b32 v[186:187], v246 offset0:44 offset1:45
  v_add_u32 v250, s5, v248
  ds_read_b128 v[212:215], v250 offset:16
  s_waitcnt lgkmcnt(9)
  v_mfma_f32_16x16x32_bf16 v[228:231], v[204:207], v[168:171], 0
  v_cvt_pk_bf16_f32 v220, v220, v221
  v_cvt_pk_bf16_f32 v221, v222, v223
  v_mfma_f32_16x16x32_bf16 v[232:235], v[204:207], v[172:175], 0
  v_cvt_pk_bf16_f32 v222, v224, v225
  v_cvt_pk_bf16_f32 v223, v226, v227
  s_waitcnt lgkmcnt(0)
  v_mfma_f32_16x16x32_bf16 v[236:239], v[212:215], v[168:171], 0
  s_nop 0
  v_cvt_pk_bf16_f32 v228, v228, v229
  v_cvt_pk_bf16_f32 v229, v230, v231
  v_mfma_f32_16x16x32_bf16 v[240:243], v[212:215], v[172:175], 0
  v_cvt_pk_bf16_f32 v230, v232, v233
  v_cvt_pk_bf16_f32 v231, v234, v235
  v_mfma_f32_16x16x32_bf16 v[156:159], v[188:191], v[212:215], v[156:159]
  v_mfma_f32_16x16x32_bf16 v[152:155], v[220:223], v[176:179], v[152:155]
  v_mfma_f32_16x16x32_bf16 v[156:159], v[228:231], v[180:183], v[156:159]
  v_cvt_pk_bf16_f32 v236, v236, v237
  v_cvt_pk_bf16_f32 v237, v238, v239
  s_nop 0
  v_cvt_pk_bf16_f32 v238, v240, v241
  v_cvt_pk_bf16_f32 v239, v242, v243
  s_nop 1
  v_mfma_f32_16x16x32_bf16 v[152:155], v[236:239], v[184:187], v[152:155]
  ds_read_b128 v[168:171], v249 offset:2048
  ds_read_b128 v[172:175], v249 offset:3072
  v_add_u32 v250, s3, v248
  ds_read_b128 v[196:199], v250 offset:16
  ds_read_b128 v[200:203], v250
  v_add_u32 v251, s4, v248
  ds_read_b128 v[204:207], v251 offset:16
  ds_read_b128 v[208:211], v251
  s_waitcnt lgkmcnt(3)
  v_mfma_f32_16x16x32_bf16 v[220:223], v[196:199], v[168:171], 0
  ds_read2_b32 v[176:177], v246 offset0:96 offset1:97
  ds_read2_b32 v[178:179], v246 offset0:132 offset1:133
  s_waitcnt lgkmcnt(4)
  v_mfma_f32_16x16x32_bf16 v[224:227], v[200:203], v[172:175], 0
  ds_read2_b32 v[180:181], v246 offset0:88 offset1:89
  ds_read2_b32 v[182:183], v246 offset0:124 offset1:125
  ds_read2_b32 v[184:185], v246 offset0:80 offset1:81
  ds_read2_b32 v[186:187], v246 offset0:116 offset1:117
  v_add_u32 v250, s5, v248
  ds_read_b128 v[212:215], v250 offset:16
  ds_read_b128 v[216:219], v250
  s_waitcnt lgkmcnt(9)
  v_mfma_f32_16x16x32_bf16 v[228:231], v[204:207], v[168:171], 0
  v_cvt_pk_bf16_f32 v220, v220, v221
  v_cvt_pk_bf16_f32 v221, v222, v223
  s_waitcnt lgkmcnt(8)
  v_mfma_f32_16x16x32_bf16 v[232:235], v[208:211], v[172:175], 0
  v_cvt_pk_bf16_f32 v222, v224, v225
  v_cvt_pk_bf16_f32 v223, v226, v227
  s_waitcnt lgkmcnt(1)
  v_mfma_f32_16x16x32_bf16 v[236:239], v[212:215], v[168:171], 0
  v_cvt_pk_bf16_f32 v228, v228, v229
  v_cvt_pk_bf16_f32 v229, v230, v231
  s_waitcnt lgkmcnt(0)
  v_mfma_f32_16x16x32_bf16 v[240:243], v[216:219], v[172:175], 0
  v_cvt_pk_bf16_f32 v230, v232, v233
  v_cvt_pk_bf16_f32 v231, v234, v235
  v_mfma_f32_16x16x32_bf16 v[156:159], v[220:223], v[176:179], v[156:159]
  s_nop 0
  v_mfma_f32_16x16x32_bf16 v[152:155], v[228:231], v[180:183], v[152:155]
  v_cvt_pk_bf16_f32 v236, v236, v237
  v_cvt_pk_bf16_f32 v237, v238, v239
  s_nop 0
  v_cvt_pk_bf16_f32 v238, v240, v241
  v_cvt_pk_bf16_f32 v239, v242, v243
  s_nop 1
  v_mfma_f32_16x16x32_bf16 v[156:159], v[236:239], v[184:187], v[156:159]
  ds_read_b128 v[168:171], v249 offset:4096
  ds_read_b128 v[172:175], v249 offset:5120
  v_add_u32 v250, s5, v248
  ds_read_b128 v[196:199], v250 offset:16
  ds_read_b128 v[200:203], v250
  v_add_u32 v251, s6, v248
  ds_read_b128 v[204:207], v251 offset:16
  ds_read_b128 v[208:211], v251
  s_waitcnt lgkmcnt(3)
  v_mfma_f32_16x16x32_bf16 v[220:223], v[196:199], v[168:171], 0
  ds_read2_b32 v[176:177], v246 offset0:180 offset1:181
  ds_read2_b32 v[178:179], v246 offset0:228 offset1:229
  s_waitcnt lgkmcnt(4)
  v_mfma_f32_16x16x32_bf16 v[224:227], v[200:203], v[172:175], 0
  ds_read2_b32 v[180:181], v246 offset0:172 offset1:173
  ds_read2_b32 v[182:183], v246 offset0:220 offset1:221
  ds_read2_b32 v[184:185], v246 offset0:164 offset1:165
  ds_read2_b32 v[186:187], v246 offset0:212 offset1:213
  ds_read2_b32 v[188:189], v246 offset0:156 offset1:157
  ds_read2_b32 v[190:191], v246 offset0:204 offset1:205
  v_add_u32 v250, s7, v248
  ds_read_b128 v[212:215], v250 offset:16
  ds_read_b128 v[216:219], v250
  s_waitcnt lgkmcnt(11)
  v_mfma_f32_16x16x32_bf16 v[228:231], v[204:207], v[168:171], 0
  v_add_u32 v251, s8, v248
  ds_read_b128 v[196:199], v251 offset:16
  ds_read_b128 v[200:203], v251
  s_waitcnt lgkmcnt(12)
  v_mfma_f32_16x16x32_bf16 v[232:235], v[208:211], v[172:175], 0
  v_cvt_pk_bf16_f32 v220, v220, v221
  v_cvt_pk_bf16_f32 v221, v222, v223
  v_cvt_pk_bf16_f32 v222, v224, v225
  v_cvt_pk_bf16_f32 v223, v226, v227
  s_waitcnt lgkmcnt(3)
  v_mfma_f32_16x16x32_bf16 v[236:239], v[212:215], v[168:171], 0
  v_cvt_pk_bf16_f32 v228, v228, v229
  v_cvt_pk_bf16_f32 v229, v230, v231
  s_waitcnt lgkmcnt(2)
  v_mfma_f32_16x16x32_bf16 v[240:243], v[216:219], v[172:175], 0
  v_cvt_pk_bf16_f32 v230, v232, v233
  v_cvt_pk_bf16_f32 v231, v234, v235
  v_mfma_f32_16x16x32_bf16 v[152:155], v[220:223], v[176:179], v[152:155]
  s_waitcnt lgkmcnt(1)
  v_mfma_f32_16x16x32_bf16 v[220:223], v[196:199], v[168:171], 0
  v_cvt_pk_bf16_f32 v236, v236, v237
  v_cvt_pk_bf16_f32 v237, v238, v239
  s_waitcnt lgkmcnt(0)
  v_mfma_f32_16x16x32_bf16 v[224:227], v[200:203], v[172:175], 0
  v_cvt_pk_bf16_f32 v238, v240, v241
  v_cvt_pk_bf16_f32 v239, v242, v243
  v_mfma_f32_16x16x32_bf16 v[156:159], v[228:231], v[180:183], v[156:159]
  s_nop 0
  v_mfma_f32_16x16x32_bf16 v[152:155], v[236:239], v[184:187], v[152:155]
  v_cvt_pk_bf16_f32 v220, v220, v221
  v_cvt_pk_bf16_f32 v221, v222, v223
  s_nop 0
  v_cvt_pk_bf16_f32 v222, v224, v225
  v_cvt_pk_bf16_f32 v223, v226, v227
  s_nop 1
  v_mfma_f32_16x16x32_bf16 v[156:159], v[220:223], v[188:191], v[156:159]
  s_nop 7
  v_pk_add_f32 v[152:153], v[152:153], v[156:157]
  v_pk_add_f32 v[154:155], v[154:155], v[158:159]
  s_add_u32 s73, s89, 8
  s_lshl_b32 s74, s73, 12
  s_add_u32 s74, s74, s76
  s_add_u32 s74, s74, 5505024
  v_lshlrev_b32 v5, 5, v2
  v_lshl_add_u32 v5, v3, 3, v5
  v_add_u32 v5, s64, v5
  v_add_u32 v6, s64, v4
  v_cvt_pk_bf16_f32 v168, v152, v153
  v_cvt_pk_bf16_f32 v169, v154, v155
  ds_write_b64 v5, v[168:169]
  ds_read_b128 v[172:175], v6
  s_mov_b32 exec_hi, 0
  s_waitcnt lgkmcnt(0)
  buffer_store_dwordx4 v[172:175], v4, s[44:47], s74 offen sc1
  s_mov_b32 exec_hi, -1
L_Afinal:
  s_and_b32 s87, s2, 255
  s_lshl_b32 s87, s87, 7
  s_add_u32 s87, s87, 12419072
  v_mov_b32 v241, 0
  buffer_load_dword v240, v241, s[44:47], s87 offen sc1
  s_lshl_b32 s70, s62, 3
  s_lshr_b32 s72, s63, 2
  s_add_u32 s70, s70, s72
  s_and_b32 s71, s63, 3
  s_and_b32 s79, s61, 1
  s_mov_b64 s[56:57], s[38:39]
  s_mov_b32 s58, 4718592
  s_mov_b32 s59, 0x20000
  s_sub_u32 s76, s11, s10
  v_lshl_add_u32 v244, s76, 1, v4
  v_add_u32 v253, s76, v4
  s_sub_u32 s76, s12, s10
  v_lshl_add_u32 v245, s76, 1, v4
  v_add_u32 v254, s76, v4
  s_sub_u32 s76, s13, s10
  v_lshl_add_u32 v246, s76, 1, v4
  v_add_u32 v0, s76, v4
  s_sub_u32 s76, s14, s10
  v_lshl_add_u32 v247, s76, 1, v4
  v_add_u32 v7, s76, v4
  s_mul_i32 s76, s70, 49152
  s_mul_i32 s72, s61, 12288
  s_add_u32 s76, s76, s72
  s_add_u32 s76, s76, 9043968
  s_add_u32 s77, s76, 4096
  s_add_u32 s78, s76, 8192
  v_and_b32 v5, 3, v1
  v_mul_u32_u24 v5, 3072, v5
  v_add_u32 v5, 3068, v5
  s_lshr_b32 s72, s61, 1
  s_lshl_b32 s72, s72, 11
  s_lshl_b32 s75, s79, 3
  s_add_u32 s72, s72, s75
  s_add_u32 s72, s72, 32768
  v_add_u32 v248, s72, v4
  s_mov_b32 s82, 0x05040100
  s_mov_b32 s83, 0x07060302
  s_lshl_b32 s72, s61, 12
  s_add_u32 s72, s72, 61440
  v_lshlrev_b32 v249, 6, v2
  v_lshl_add_u32 v249, v3, 4, v249
  v_add_u32 v249, s72, v249
  v_add_u32 v250, s72, v4
  v_lshrrev_b32 v251, 2, v1
  v_mul_u32_u24 v251, 2304, v251
  v_and_b32 v6, 3, v1
  v_lshl_add_u32 v251, v6, 4, v251
  v_mul_u32_u24 v252, 2304, v2
  v_lshl_add_u32 v252, v3, 3, v252
  s_mul_i32 s84, s70, 73728
  s_mul_i32 s85, s71, 288
  s_add_u32 s84, s84, s85
  s_add_u32 s84, s84, 1152
  s_mul_i32 s86, s79, 36864
  s_add_u32 s86, s86, s84
  s_lshl_b32 s85, s61, 6
  s_add_u32 s84, s84, s85
  s_add_u32 s85, s84, 36864
  s_lshl_b32 s80, s62, 12
  s_lshl_b32 s81, s63, 7
  s_add_u32 s80, s80, s81
  s_add_u32 s80, s80, 12386304
  v_mov_b32 v242, s60
  s_waitcnt vmcnt(0)
  s_barrier
  s_cmp_lg_u32 s61, 0
  s_cbranch_scc1 Lny_17
  s_mov_b64 exec, 1
  buffer_store_dword v242, v4, s[44:47], s80 offen sc1
  s_mov_b64 exec, -1
Lny_17:
  s_setprio 2
  v_cmp_ne_u32 vcc, s60, v240
  s_nop 0
  s_cbranch_vccz Lh_18
  s_waitcnt vmcnt(0) lgkmcnt(0)
  s_movk_i32 s65, 3000
Lpoll_19:
  buffer_load_dword v240, v241, s[44:47], s87 offen sc1
  s_sub_u32 s65, s65, 1
  s_cbranch_scc1 Lpolld_20x
  s_waitcnt vmcnt(0)
  v_cmp_ne_u32 vcc, s60, v240
  s_nop 0
  s_cbranch_vccz Lpolld_20
  s_sleep 2
  s_branch Lpoll_19
Lpolld_20x:
  s_waitcnt vmcnt(0)
Lpolld_20:
Lh_18:
  s_movk_i32 s88, 40
Lg_21:
  buffer_load_dwordx4 v[152:155], v4, s[44:47], s76 offen offset:0 sc1
  buffer_load_dwordx4 v[156:159], v4, s[44:47], s76 offen offset:1024 sc1
  buffer_load_dwordx4 v[160:163], v4, s[44:47], s76 offen offset:2048 sc1
  buffer_load_dwordx4 v[164:167], v4, s[44:47], s76 offen offset:3072 sc1
  buffer_load_dwordx4 v[168:171], v4, s[44:47], s77 offen offset:0 sc1
  buffer_load_dwordx4 v[172:175], v4, s[44:47], s77 offen offset:1024 sc1
  buffer_load_dwordx4 v[176:179], v4, s[44:47], s77 offen offset:2048 sc1
  buffer_load_dwordx4 v[180:183], v4, s[44:47], s77 offen offset:3072 sc1
  buffer_load_dwordx4 v[184:187], v4, s[44:47], s78 offen offset:0 sc1
  buffer_load_dwordx4 v[188:191], v4, s[44:47], s78 offen offset:1024 sc1
  buffer_load_dwordx4 v[192:195], v4, s[44:47], s78 offen offset:2048 sc1
  buffer_load_dwordx4 v[196:199], v4, s[44:47], s78 offen offset:3072 sc1
  s_waitcnt vmcnt(11)
  v_xor_b32 v6, s60, v155
  s_waitcnt vmcnt(10)
  v_bitop3_b32 v6, v6, v159, s60 bitop3:0xf6
  s_waitcnt vmcnt(9)
  v_bitop3_b32 v6, v6, v163, s60 bitop3:0xf6
  s_waitcnt vmcnt(8)
  v_bitop3_b32 v6, v6, v167, s60 bitop3:0xf6
  s_waitcnt vmcnt(7)
  v_bitop3_b32 v6, v6, v171, s60 bitop3:0xf6
  s_waitcnt vmcnt(6)
  v_bitop3_b32 v6, v6, v175, s60 bitop3:0xf6
  s_waitcnt vmcnt(5)
  v_bitop3_b32 v6, v6, v179, s60 bitop3:0xf6
  s_waitcnt vmcnt(4)
  v_bitop3_b32 v6, v6, v183, s60 bitop3:0xf6
  s_waitcnt vmcnt(3)
  v_bitop3_b32 v6, v6, v187, s60 bitop3:0xf6
  s_waitcnt vmcnt(2)
  v_bitop3_b32 v6, v6, v191, s60 bitop3:0xf6
  s_waitcnt vmcnt(1)
  v_bitop3_b32 v6, v6, v195, s60 bitop3:0xf6
  s_waitcnt vmcnt(0)
  v_bitop3_b32 v6, v6, v199, s60 bitop3:0xf6
  v_cmp_ne_u32 vcc, 0, v6
  s_sub_u32 s88, s88, 1
  s_cbranch_scc1 Lgd_22
  s_cbranch_vccz Lgd_22
  s_waitcnt vmcnt(0) lgkmcnt(0)
  s_movk_i32 s65, 3000
Lpoll_23:
  buffer_load_dword v6, v5, s[44:47], s76 offen sc1
  s_sub_u32 s65, s65, 1
  s_cbranch_scc1 Lpolld_24x
  s_waitcnt vmcnt(0)
  v_cmp_ne_u32 vcc, s60, v6
  s_nop 0
  s_cbranch_vccz Lpolld_24
  s_sleep 2
  s_branch Lpoll_23
Lpolld_24x:
  s_waitcnt vmcnt(0)
Lpolld_24:
  s_branch Lg_21
Lgd_22:
  v_mov_b32 v155, v160
  v_mov_b32 v159, v161
  ds_write_b128 v244, v[152:155] offset:0
  ds_write_b128 v244, v[156:159] offset:1024
  v_mov_b32 v167, v172
  v_mov_b32 v171, v173
  ds_write_b128 v244, v[164:167] offset:2048
  ds_write_b128 v244, v[168:171] offset:3072
  v_mov_b32 v179, v184
  v_mov_b32 v183, v185
  ds_write_b128 v244, v[176:179] offset:4096
  ds_write_b128 v244, v[180:183] offset:5120
  v_mov_b32 v191, v196
  v_mov_b32 v195, v197
  ds_write_b128 v244, v[188:191] offset:6144
  ds_write_b128 v244, v[192:195] offset:7168
  v_perm_b32 v220, v174, v162, s82
  v_perm_b32 v222, v174, v162, s83
  v_perm_b32 v221, v198, v186, s82
  v_perm_b32 v223, v198, v186, s83
  ds_write2_b64 v248, v[220:221], v[222:223] offset0:0 offset1:128
  v_mfma_f32_16x16x32_bf16 v[200:203], v[8:11], v[152:155], 0
  v_mfma_f32_16x16x32_bf16 v[208:211], v[80:83], v[152:155], 0
  v_mfma_f32_16x16x32_bf16 v[204:207], v[8:11], v[156:159], 0
  v_mfma_f32_16x16x32_bf16 v[212:215], v[80:83], v[156:159], 0
  v_mfma_f32_16x16x32_bf16 v[200:203], v[12:15], v[164:167], v[200:203]
  v_mfma_f32_16x16x32_bf16 v[208:211], v[84:87], v[164:167], v[208:211]
  v_mfma_f32_16x16x32_bf16 v[204:207], v[12:15], v[168:171], v[204:207]
  v_mfma_f32_16x16x32_bf16 v[212:215], v[84:87], v[168:171], v[212:215]
  v_mfma_f32_16x16x32_bf16 v[200:203], v[16:19], v[176:179], v[200:203]
  v_mfma_f32_16x16x32_bf16 v[208:211], v[88:91], v[176:179], v[208:211]
  v_mfma_f32_16x16x32_bf16 v[204:207], v[16:19], v[180:183], v[204:207]
  v_mfma_f32_16x16x32_bf16 v[212:215], v[88:91], v[180:183], v[212:215]
  v_mfma_f32_16x16x32_bf16 v[200:203], v[20:23], v[188:191], v[200:203]
  v_mfma_f32_16x16x32_bf16 v[208:211], v[92:95], v[188:191], v[208:211]
  v_mfma_f32_16x16x32_bf16 v[204:207], v[20:23], v[192:195], v[204:207]
  v_mfma_f32_16x16x32_bf16 v[212:215], v[92:95], v[192:195], v[212:215]
  s_waitcnt lgkmcnt(0)
  s_barrier
  s_cmp_ge_u32 s61, 2
  s_cbranch_scc1 Lt8_26
  ds_read_b128 v[228:231], v245 offset:0
  ds_read_b128 v[232:235], v245 offset:1024
  ds_read_b128 v[236:239], v245 offset:2048
  ds_read_b128 v[240:243], v245 offset:3072
  s_waitcnt lgkmcnt(2)
  v_mfma_f32_16x16x32_bf16 v[200:203], v[24:27], v[228:231], v[200:203]
  ds_read_b128 v[220:223], v245 offset:4096
  v_mfma_f32_16x16x32_bf16 v[208:211], v[96:99], v[228:231], v[208:211]
  ds_read_b128 v[224:227], v245 offset:5120
  v_mfma_f32_16x16x32_bf16 v[204:207], v[24:27], v[232:235], v[204:207]
  v_mfma_f32_16x16x32_bf16 v[212:215], v[96:99], v[232:235], v[212:215]
  s_waitcnt lgkmcnt(2)
  v_mfma_f32_16x16x32_bf16 v[200:203], v[28:31], v[236:239], v[200:203]
  ds_read_b128 v[228:231], v245 offset:6144
  v_mfma_f32_16x16x32_bf16 v[208:211], v[100:103], v[236:239], v[208:211]
  ds_read_b128 v[232:235], v245 offset:7168
  v_mfma_f32_16x16x32_bf16 v[204:207], v[28:31], v[240:243], v[204:207]
  v_mfma_f32_16x16x32_bf16 v[212:215], v[100:103], v[240:243], v[212:215]
  s_waitcnt lgkmcnt(2)
  v_mfma_f32_16x16x32_bf16 v[200:203], v[32:35], v[220:223], v[200:203]
  ds_read_b128 v[236:239], v246 offset:0
  v_mfma_f32_16x16x32_bf16 v[208:211], v[104:107], v[220:223], v[208:211]
  ds_read_b128 v[240:243], v246 offset:1024
  v_mfma_f32_16x16x32_bf16 v[204:207], v[32:35], v[224:227], v[204:207]
  v_mfma_f32_16x16x32_bf16 v[212:215], v[104:107], v[224:227], v[212:215]
  s_waitcnt lgkmcnt(2)
  v_mfma_f32_16x16x32_bf16 v[200:203], v[36:39], v[228:231], v[200:203]
  ds_read_b128 v[220:223], v246 offset:2048
  v_mfma_f32_16x16x32_bf16 v[208:211], v[108:111], v[228:231], v[208:211]
  ds_read_b128 v[224:227], v246 offset:3072
  v_mfma_f32_16x16x32_bf16 v[204:207], v[36:39], v[232:235], v[204:207]
  v_mfma_f32_16x16x32_bf16 v[212:215], v[108:111], v[232:235], v[212:215]
  s_waitcnt lgkmcnt(2)
  v_mfma_f32_16x16x32_bf16 v[200:203], v[40:43], v[236:239], v[200:203]
  ds_read_b128 v[228:231], v246 offset:4096
  v_mfma_f32_16x16x32_bf16 v[208:211], v[112:115], v[236:239], v[208:211]
  ds_read_b128 v[232:235], v246 offset:5120
  v_mfma_f32_16x16x32_bf16 v[204:207], v[40:43], v[240:243], v[204:207]
  v_mfma_f32_16x16x32_bf16 v[212:215], v[112:115], v[240:243], v[212:215]
  s_waitcnt lgkmcnt(2)
  v_mfma_f32_16x16x32_bf16 v[200:203], v[44:47], v[220:223], v[200:203]
  ds_read_b128 v[236:239], v246 offset:6144
  v_mfma_f32_16x16x32_bf16 v[208:211], v[116:119], v[220:223], v[208:211]
  ds_read_b128 v[240:243], v246 offset:7168
  v_mfma_f32_16x16x32_bf16 v[204:207], v[44:47], v[224:227], v[204:207]
  v_mfma_f32_16x16x32_bf16 v[212:215], v[116:119], v[224:227], v[212:215]
  s_waitcnt lgkmcnt(2)
  v_mfma_f32_16x16x32_bf16 v[200:203], v[48:51], v[228:231], v[200:203]
  ds_read_b128 v[220:223], v247 offset:0
  v_mfma_f32_16x16x32_bf16 v[208:211], v[120:123], v[228:231], v[208:211]
  ds_read_b128 v[224:227], v247 offset:1024
  v_mfma_f32_16x16x32_bf16 v[204:207], v[48:51], v[232:235], v[204:207]
  v_mfma_f32_16x16x32_bf16 v[212:215], v[120:123], v[232:235], v[212:215]
  s_waitcnt lgkmcnt(2)
  v_mfma_f32_16x16x32_bf16 v[200:203], v[52:55], v[236:239], v[200:203]
  ds_read_b128 v[228:231], v247 offset:2048
  v_mfma_f32_16x16x32_bf16 v[208:211], v[124:127], v[236:239], v[208:211]
  ds_read_b128 v[232:235], v247 offset:3072
  v_mfma_f32_16x16x32_bf16 v[204:207], v[52:55], v[240:243], v[204:207]
  v_mfma_f32_16x16x32_bf16 v[212:215], v[124:127], v[240:243], v[212:215]
  s_waitcnt lgkmcnt(2)
  v_mfma_f32_16x16x32_bf16 v[200:203], v[56:59], v[220:223], v[200:203]
  ds_read_b128 v[236:239], v247 offset:4096
  v_mfma_f32_16x16x32_bf16 v[208:211], v[128:131], v[220:223], v[208:211]
  ds_read_b128 v[240:243], v247 offset:5120
  v_mfma_f32_16x16x32_bf16 v[204:207], v[56:59], v[224:227], v[204:207]
  v_mfma_f32_16x16x32_bf16 v[212:215], v[128:131], v[224:227], v[212:215]
  s_waitcnt lgkmcnt(2)
  v_mfma_f32_16x16x32_bf16 v[200:203], v[60:63], v[228:231], v[200:203]
  ds_read_b128 v[220:223], v247 offset:6144
  v_mfma_f32_16x16x32_bf16 v[208:211], v[132:135], v[228:231], v[208:211]
  ds_read_b128 v[224:227], v247 offset:7168
  v_mfma_f32_16x16x32_bf16 v[204:207], v[60:63], v[232:235], v[204:207]
  v_mfma_f32_16x16x32_bf16 v[212:215], v[132:135], v[232:235], v[212:215]
  s_waitcnt lgkmcnt(2)
  v_mfma_f32_16x16x32_bf16 v[200:203], v[64:67], v[236:239], v[200:203]
  ds_read_b128 v[228:231], v4 offset:32768
  v_mfma_f32_16x16x32_bf16 v[208:211], v[136:139], v[236:239], v[208:211]
  ds_read_b128 v[232:235], v4 offset:33792
  v_mfma_f32_16x16x32_bf16 v[204:207], v[64:67], v[240:243], v[204:207]
  v_mfma_f32_16x16x32_bf16 v[212:215], v[136:139], v[240:243], v[212:215]
  s_waitcnt lgkmcnt(2)
  v_mfma_f32_16x16x32_bf16 v[200:203], v[68:71], v[220:223], v[200:203]
  ds_read_b128 v[236:239], v4 offset:34816
  v_mfma_f32_16x16x32_bf16 v[208:211], v[140:143], v[220:223], v[208:211]
  ds_read_b128 v[240:243], v4 offset:35840
  v_mfma_f32_16x16x32_bf16 v[204:207], v[68:71], v[224:227], v[204:207]
  v_mfma_f32_16x16x32_bf16 v[212:215], v[140:143], v[224:227], v[212:215]
  s_waitcnt lgkmcnt(2)
  v_mfma_f32_16x16x32_bf16 v[200:203], v[72:75], v[228:231], v[200:203]
  v_mfma_f32_16x16x32_bf16 v[208:211], v[144:147], v[228:231], v[208:211]
  v_mfma_f32_16x16x32_bf16 v[204:207], v[72:75], v[232:235], v[204:207]
  v_mfma_f32_16x16x32_bf16 v[212:215], v[144:147], v[232:235], v[212:215]
  s_waitcnt lgkmcnt(0)
  v_mfma_f32_16x16x32_bf16 v[200:203], v[76:79], v[236:239], v[200:203]
  v_mfma_f32_16x16x32_bf16 v[208:211], v[148:151], v[236:239], v[208:211]
  v_mfma_f32_16x16x32_bf16 v[204:207], v[76:79], v[240:243], v[204:207]
  v_mfma_f32_16x16x32_bf16 v[212:215], v[148:151], v[240:243], v[212:215]
  s_nop 4
  v_cvt_pk_bf16_f32 v220, v200, v201
  v_cvt_pk_bf16_f32 v221, v202, v203
  v_cvt_pk_bf16_f32 v222, v208, v209
  v_cvt_pk_bf16_f32 v223, v210, v211
  ds_write_b128 v249, v[220:223] offset:0
  v_cvt_pk_bf16_f32 v224, v204, v205
  v_cvt_pk_bf16_f32 v225, v206, v207
  v_cvt_pk_bf16_f32 v226, v212, v213
  v_cvt_pk_bf16_f32 v227, v214, v215
  ds_write_b128 v249, v[224:227] offset:1024
  ds_read_b128 v[228:231], v250 offset:0
  ds_read_b128 v[232:235], v250 offset:1024
  s_waitcnt lgkmcnt(1)
  buffer_store_dwordx4 v[228:231], v251, s[56:59], s84 offen
  s_waitcnt lgkmcnt(0)
  buffer_store_dwordx4 v[232:235], v251, s[56:59], s85 offen
  s_branch Lfin_25
Lt8_26:
  s_cmp_eq_u32 s61, 3
  s_cbranch_scc1 Lw3_27
  ds_read_b128 v[160:163], v253 offset:40960
  ds_read_b128 v[172:175], v253 offset:41984
  ds_read_b128 v[184:187], v253 offset:43008
  ds_read_b128 v[196:199], v253 offset:44032
  ds_read_b128 v[228:231], v245 offset:0
  ds_read_b128 v[232:235], v245 offset:1024
  ds_read_b128 v[236:239], v245 offset:2048
  ds_read_b128 v[240:243], v245 offset:3072
  s_waitcnt lgkmcnt(7)
  v_mfma_f32_16x16x32_bf16 v[216:219], v[160:163], v[152:155], 0
  s_waitcnt lgkmcnt(6)
  v_mfma_f32_16x16x32_bf16 v[216:219], v[172:175], v[164:167], v[216:219]
  ds_read_b128 v[160:163], v254 offset:40960
  s_waitcnt lgkmcnt(6)
  v_mfma_f32_16x16x32_bf16 v[216:219], v[184:187], v[176:179], v[216:219]
  ds_read_b128 v[172:175], v254 offset:41984
  s_waitcnt lgkmcnt(6)
  v_mfma_f32_16x16x32_bf16 v[216:219], v[196:199], v[188:191], v[216:219]
  s_waitcnt lgkmcnt(1)
  v_mfma_f32_16x16x32_bf16 v[200:203], v[24:27], v[228:231], v[200:203]
  ds_read_b128 v[220:223], v245 offset:4096
  v_mfma_f32_16x16x32_bf16 v[208:211], v[96:99], v[228:231], v[208:211]
  ds_read_b128 v[224:227], v245 offset:5120
  v_mfma_f32_16x16x32_bf16 v[204:207], v[24:27], v[232:235], v[204:207]
  ds_read_b128 v[184:187], v254 offset:43008
  v_mfma_f32_16x16x32_bf16 v[212:215], v[96:99], v[232:235], v[212:215]
  v_mfma_f32_16x16x32_bf16 v[216:219], v[160:163], v[228:231], v[216:219]
  s_waitcnt lgkmcnt(3)
  v_mfma_f32_16x16x32_bf16 v[200:203], v[28:31], v[236:239], v[200:203]
  ds_read_b128 v[228:231], v245 offset:6144
  v_mfma_f32_16x16x32_bf16 v[208:211], v[100:103], v[236:239], v[208:211]
  ds_read_b128 v[232:235], v245 offset:7168
  v_mfma_f32_16x16x32_bf16 v[204:207], v[28:31], v[240:243], v[204:207]
  ds_read_b128 v[196:199], v254 offset:44032
  v_mfma_f32_16x16x32_bf16 v[212:215], v[100:103], v[240:243], v[212:215]
  v_mfma_f32_16x16x32_bf16 v[216:219], v[172:175], v[236:239], v[216:219]
  s_waitcnt lgkmcnt(3)
  v_mfma_f32_16x16x32_bf16 v[200:203], v[32:35], v[220:223], v[200:203]
  ds_read_b128 v[236:239], v246 offset:0
  v_mfma_f32_16x16x32_bf16 v[208:211], v[104:107], v[220:223], v[208:211]
  ds_read_b128 v[240:243], v246 offset:1024
  v_mfma_f32_16x16x32_bf16 v[204:207], v[32:35], v[224:227], v[204:207]
  ds_read_b128 v[160:163], v0 offset:40960
  v_mfma_f32_16x16x32_bf16 v[212:215], v[104:107], v[224:227], v[212:215]
  v_mfma_f32_16x16x32_bf16 v[216:219], v[184:187], v[220:223], v[216:219]
  s_waitcnt lgkmcnt(3)
  v_mfma_f32_16x16x32_bf16 v[200:203], v[36:39], v[228:231], v[200:203]
  ds_read_b128 v[220:223], v246 offset:2048
  v_mfma_f32_16x16x32_bf16 v[208:211], v[108:111], v[228:231], v[208:211]
  ds_read_b128 v[224:227], v246 offset:3072
  v_mfma_f32_16x16x32_bf16 v[204:207], v[36:39], v[232:235], v[204:207]
  ds_read_b128 v[172:175], v0 offset:41984
  v_mfma_f32_16x16x32_bf16 v[212:215], v[108:111], v[232:235], v[212:215]
  v_mfma_f32_16x16x32_bf16 v[216:219], v[196:199], v[228:231], v[216:219]
  s_waitcnt lgkmcnt(3)
  v_mfma_f32_16x16x32_bf16 v[200:203], v[40:43], v[236:239], v[200:203]
  ds_read_b128 v[228:231], v246 offset:4096
  v_mfma_f32_16x16x32_bf16 v[208:211], v[112:115], v[236:239], v[208:211]
  ds_read_b128 v[232:235], v246 offset:5120
  v_mfma_f32_16x16x32_bf16 v[204:207], v[40:43], v[240:243], v[204:207]
  ds_read_b128 v[184:187], v0 offset:43008
  v_mfma_f32_16x16x32_bf16 v[212:215], v[112:115], v[240:243], v[212:215]
  v_mfma_f32_16x16x32_bf16 v[216:219], v[160:163], v[236:239], v[216:219]
  s_waitcnt lgkmcnt(3)
  v_mfma_f32_16x16x32_bf16 v[200:203], v[44:47], v[220:223], v[200:203]
  ds_read_b128 v[236:239], v246 offset:6144
  v_mfma_f32_16x16x32_bf16 v[208:211], v[116:119], v[220:223], v[208:211]
  ds_read_b128 v[240:243], v246 offset:7168
  v_mfma_f32_16x16x32_bf16 v[204:207], v[44:47], v[224:227], v[204:207]
  ds_read_b128 v[196:199], v0 offset:44032
  v_mfma_f32_16x16x32_bf16 v[212:215], v[116:119], v[224:227], v[212:215]
  v_mfma_f32_16x16x32_bf16 v[216:219], v[172:175], v[220:223], v[216:219]
  s_waitcnt lgkmcnt(3)
  v_mfma_f32_16x16x32_bf16 v[200:203], v[48:51], v[228:231], v[200:203]
  ds_read_b128 v[220:223], v247 offset:0
  v_mfma_f32_16x16x32_bf16 v[208:211], v[120:123], v[228:231], v[208:211]
  ds_read_b128 v[224:227], v247 offset:1024
  v_mfma_f32_16x16x32_bf16 v[204:207], v[48:51], v[232:235], v[204:207]
  ds_read_b128 v[160:163], v7 offset:40960
  v_mfma_f32_16x16x32_bf16 v[212:215], v[120:123], v[232:235], v[212:215]
  v_mfma_f32_16x16x32_bf16 v[216:219], v[184:187], v[228:231], v[216:219]
  s_waitcnt lgkmcnt(3)
  v_mfma_f32_16x16x32_bf16 v[200:203], v[52:55], v[236:239], v[200:203]
  ds_read_b128 v[228:231], v247 offset:2048
  v_mfma_f32_16x16x32_bf16 v[208:211], v[124:127], v[236:239], v[208:211]
  ds_read_b128 v[232:235], v247 offset:3072
  v_mfma_f32_16x16x32_bf16 v[204:207], v[52:55], v[240:243], v[204:207]
  ds_read_b128 v[172:175], v7 offset:41984
  v_mfma_f32_16x16x32_bf16 v[212:215], v[124:127], v[240:243], v[212:215]
  v_mfma_f32_16x16x32_bf16 v[216:219], v[196:199], v[236:239], v[216:219]
  s_waitcnt lgkmcnt(3)
  v_mfma_f32_16x16x32_bf16 v[200:203], v[56:59], v[220:223], v[200:203]
  ds_read_b128 v[236:239], v247 offset:4096
  v_mfma_f32_16x16x32_bf16 v[208:211], v[128:131], v[220:223], v[208:211]
  ds_read_b128 v[240:243], v247 offset:5120
  v_mfma_f32_16x16x32_bf16 v[204:207], v[56:59], v[224:227], v[204:207]
  ds_read_b128 v[184:187], v7 offset:43008
  v_mfma_f32_16x16x32_bf16 v[212:215], v[128:131], v[224:227], v[212:215]
  v_mfma_f32_16x16x32_bf16 v[216:219], v[160:163], v[220:223], v[216:219]
  s_waitcnt lgkmcnt(3)
  v_mfma_f32_16x16x32_bf16 v[200:203], v[60:63], v[228:231], v[200:203]
  ds_read_b128 v[220:223], v247 offset:6144
  v_mfma_f32_16x16x32_bf16 v[208:211], v[132:135], v[228:231], v[208:211]
  ds_read_b128 v[224:227], v247 offset:7168
  v_mfma_f32_16x16x32_bf16 v[204:207], v[60:63], v[232:235], v[204:207]
  ds_read_b128 v[196:199], v7 offset:44032
  v_mfma_f32_16x16x32_bf16 v[212:215], v[132:135], v[232:235], v[212:215]
  v_mfma_f32_16x16x32_bf16 v[216:219], v[172:175], v[228:231], v[216:219]
  s_waitcnt lgkmcnt(3)
  v_mfma_f32_16x16x32_bf16 v[200:203], v[64:67], v[236:239], v[200:203]
  ds_read_b128 v[228:231], v4 offset:32768
  v_mfma_f32_16x16x32_bf16 v[208:211], v[136:139], v[236:239], v[208:211]
  ds_read_b128 v[232:235], v4 offset:33792
  v_mfma_f32_16x16x32_bf16 v[204:207], v[64:67], v[240:243], v[204:207]
  ds_read_b128 v[160:163], v4 offset:57344
  v_mfma_f32_16x16x32_bf16 v[212:215], v[136:139], v[240:243], v[212:215]
  v_mfma_f32_16x16x32_bf16 v[216:219], v[184:187], v[236:239], v[216:219]
  s_waitcnt lgkmcnt(3)
  v_mfma_f32_16x16x32_bf16 v[200:203], v[68:71], v[220:223], v[200:203]
  ds_read_b128 v[236:239], v4 offset:34816
  v_mfma_f32_16x16x32_bf16 v[208:211], v[140:143], v[220:223], v[208:211]
  ds_read_b128 v[240:243], v4 offset:35840
  v_mfma_f32_16x16x32_bf16 v[204:207], v[68:71], v[224:227], v[204:207]
  ds_read_b128 v[172:175], v4 offset:58368
  v_mfma_f32_16x16x32_bf16 v[212:215], v[140:143], v[224:227], v[212:215]
  v_mfma_f32_16x16x32_bf16 v[216:219], v[196:199], v[220:223], v[216:219]
  s_waitcnt lgkmcnt(3)
  v_mfma_f32_16x16x32_bf16 v[200:203], v[72:75], v[228:231], v[200:203]
  v_mfma_f32_16x16x32_bf16 v[208:211], v[144:147], v[228:231], v[208:211]
  v_mfma_f32_16x16x32_bf16 v[204:207], v[72:75], v[232:235], v[204:207]
  v_mfma_f32_16x16x32_bf16 v[212:215], v[144:147], v[232:235], v[212:215]
  v_mfma_f32_16x16x32_bf16 v[216:219], v[160:163], v[228:231], v[216:219]
  s_waitcnt lgkmcnt(0)
  v_mfma_f32_16x16x32_bf16 v[200:203], v[76:79], v[236:239], v[200:203]
  v_mfma_f32_16x16x32_bf16 v[208:211], v[148:151], v[236:239], v[208:211]
  v_mfma_f32_16x16x32_bf16 v[204:207], v[76:79], v[240:243], v[204:207]
  v_mfma_f32_16x16x32_bf16 v[212:215], v[148:151], v[240:243], v[212:215]
  v_mfma_f32_16x16x32_bf16 v[216:219], v[172:175], v[236:239], v[216:219]
  s_nop 3
  v_cvt_pk_bf16_f32 v220, v200, v201
  v_cvt_pk_bf16_f32 v221, v202, v203
  v_cvt_pk_bf16_f32 v222, v208, v209
  v_cvt_pk_bf16_f32 v223, v210, v211
  ds_write_b128 v249, v[220:223] offset:0
  v_cvt_pk_bf16_f32 v224, v204, v205
  v_cvt_pk_bf16_f32 v225, v206, v207
  v_cvt_pk_bf16_f32 v226, v212, v213
  v_cvt_pk_bf16_f32 v227, v214, v215
  ds_write_b128 v249, v[224:227] offset:1024
  ds_read_b128 v[228:231], v250 offset:0
  ds_read_b128 v[232:235], v250 offset:1024
  s_waitcnt lgkmcnt(1)
  buffer_store_dwordx4 v[228:231], v251, s[56:59], s84 offen
  s_waitcnt lgkmcnt(0)
  buffer_store_dwordx4 v[232:235], v251, s[56:59], s85 offen
  s_branch Lw23_28
Lw3_27:
  ds_read_b128 v[160:163], v253 offset:40960
  ds_read_b128 v[172:175], v253 offset:41984
  ds_read_b128 v[184:187], v253 offset:43008
  ds_read_b128 v[196:199], v253 offset:44032
  ds_read_b128 v[228:231], v245 offset:0
  ds_read_b128 v[232:235], v245 offset:1024
  ds_read_b128 v[236:239], v245 offset:2048
  ds_read_b128 v[240:243], v245 offset:3072
  s_waitcnt lgkmcnt(7)
  v_mfma_f32_16x16x32_bf16 v[216:219], v[160:163], v[156:159], 0
  s_waitcnt lgkmcnt(6)
  v_mfma_f32_16x16x32_bf16 v[216:219], v[172:175], v[168:171], v[216:219]
  ds_read_b128 v[160:163], v254 offset:40960
  s_waitcnt lgkmcnt(6)
  v_mfma_f32_16x16x32_bf16 v[216:219], v[184:187], v[180:183], v[216:219]
  ds_read_b128 v[172:175], v254 offset:41984
  s_waitcnt lgkmcnt(6)
  v_mfma_f32_16x16x32_bf16 v[216:219], v[196:199], v[192:195], v[216:219]
  s_waitcnt lgkmcnt(1)
  v_mfma_f32_16x16x32_bf16 v[200:203], v[24:27], v[228:231], v[200:203]
  ds_read_b128 v[220:223], v245 offset:4096
  v_mfma_f32_16x16x32_bf16 v[208:211], v[96:99], v[228:231], v[208:211]
  ds_read_b128 v[224:227], v245 offset:5120
  v_mfma_f32_16x16x32_bf16 v[204:207], v[24:27], v[232:235], v[204:207]
  ds_read_b128 v[184:187], v254 offset:43008
  v_mfma_f32_16x16x32_bf16 v[212:215], v[96:99], v[232:235], v[212:215]
  v_mfma_f32_16x16x32_bf16 v[216:219], v[160:163], v[232:235], v[216:219]
  s_waitcnt lgkmcnt(3)
  v_mfma_f32_16x16x32_bf16 v[200:203], v[28:31], v[236:239], v[200:203]
  ds_read_b128 v[228:231], v245 offset:6144
  v_mfma_f32_16x16x32_bf16 v[208:211], v[100:103], v[236:239], v[208:211]
  ds_read_b128 v[232:235], v245 offset:7168
  v_mfma_f32_16x16x32_bf16 v[204:207], v[28:31], v[240:243], v[204:207]
  ds_read_b128 v[196:199], v254 offset:44032
  v_mfma_f32_16x16x32_bf16 v[212:215], v[100:103], v[240:243], v[212:215]
  v_mfma_f32_16x16x32_bf16 v[216:219], v[172:175], v[240:243], v[216:219]
  s_waitcnt lgkmcnt(3)
  v_mfma_f32_16x16x32_bf16 v[200:203], v[32:35], v[220:223], v[200:203]
  ds_read_b128 v[236:239], v246 offset:0
  v_mfma_f32_16x16x32_bf16 v[208:211], v[104:107], v[220:223], v[208:211]
  ds_read_b128 v[240:243], v246 offset:1024
  v_mfma_f32_16x16x32_bf16 v[204:207], v[32:35], v[224:227], v[204:207]
  ds_read_b128 v[160:163], v0 offset:40960
  v_mfma_f32_16x16x32_bf16 v[212:215], v[104:107], v[224:227], v[212:215]
  v_mfma_f32_16x16x32_bf16 v[216:219], v[184:187], v[224:227], v[216:219]
  s_waitcnt lgkmcnt(3)
  v_mfma_f32_16x16x32_bf16 v[200:203], v[36:39], v[228:231], v[200:203]
  ds_read_b128 v[220:223], v246 offset:2048
  v_mfma_f32_16x16x32_bf16 v[208:211], v[108:111], v[228:231], v[208:211]
  ds_read_b128 v[224:227], v246 offset:3072
  v_mfma_f32_16x16x32_bf16 v[204:207], v[36:39], v[232:235], v[204:207]
  ds_read_b128 v[172:175], v0 offset:41984
  v_mfma_f32_16x16x32_bf16 v[212:215], v[108:111], v[232:235], v[212:215]
  v_mfma_f32_16x16x32_bf16 v[216:219], v[196:199], v[232:235], v[216:219]
  s_waitcnt lgkmcnt(3)
  v_mfma_f32_16x16x32_bf16 v[200:203], v[40:43], v[236:239], v[200:203]
  ds_read_b128 v[228:231], v246 offset:4096
  v_mfma_f32_16x16x32_bf16 v[208:211], v[112:115], v[236:239], v[208:211]
  ds_read_b128 v[232:235], v246 offset:5120
  v_mfma_f32_16x16x32_bf16 v[204:207], v[40:43], v[240:243], v[204:207]
  ds_read_b128 v[184:187], v0 offset:43008
  v_mfma_f32_16x16x32_bf16 v[212:215], v[112:115], v[240:243], v[212:215]
  v_mfma_f32_16x16x32_bf16 v[216:219], v[160:163], v[240:243], v[216:219]
  s_waitcnt lgkmcnt(3)
  v_mfma_f32_16x16x32_bf16 v[200:203], v[44:47], v[220:223], v[200:203]
  ds_read_b128 v[236:239], v246 offset:6144
  v_mfma_f32_16x16x32_bf16 v[208:211], v[116:119], v[220:223], v[208:211]
  ds_read_b128 v[240:243], v246 offset:7168
  v_mfma_f32_16x16x32_bf16 v[204:207], v[44:47], v[224:227], v[204:207]
  ds_read_b128 v[196:199], v0 offset:44032
  v_mfma_f32_16x16x32_bf16 v[212:215], v[116:119], v[224:227], v[212:215]
  v_mfma_f32_16x16x32_bf16 v[216:219], v[172:175], v[224:227], v[216:219]
  s_waitcnt lgkmcnt(3)
  v_mfma_f32_16x16x32_bf16 v[200:203], v[48:51], v[228:231], v[200:203]
  ds_read_b128 v[220:223], v247 offset:0
  v_mfma_f32_16x16x32_bf16 v[208:211], v[120:123], v[228:231], v[208:211]
  ds_read_b128 v[224:227], v247 offset:1024
  v_mfma_f32_16x16x32_bf16 v[204:207], v[48:51], v[232:235], v[204:207]
  ds_read_b128 v[160:163], v7 offset:40960
  v_mfma_f32_16x16x32_bf16 v[212:215], v[120:123], v[232:235], v[212:215]
  v_mfma_f32_16x16x32_bf16 v[216:219], v[184:187], v[232:235], v[216:219]
  s_waitcnt lgkmcnt(3)
  v_mfma_f32_16x16x32_bf16 v[200:203], v[52:55], v[236:239], v[200:203]
  ds_read_b128 v[228:231], v247 offset:2048
  v_mfma_f32_16x16x32_bf16 v[208:211], v[124:127], v[236:239], v[208:211]
  ds_read_b128 v[232:235], v247 offset:3072
  v_mfma_f32_16x16x32_bf16 v[204:207], v[52:55], v[240:243], v[204:207]
  ds_read_b128 v[172:175], v7 offset:41984
  v_mfma_f32_16x16x32_bf16 v[212:215], v[124:127], v[240:243], v[212:215]
  v_mfma_f32_16x16x32_bf16 v[216:219], v[196:199], v[240:243], v[216:219]
  s_waitcnt lgkmcnt(3)
  v_mfma_f32_16x16x32_bf16 v[200:203], v[56:59], v[220:223], v[200:203]
  ds_read_b128 v[236:239], v247 offset:4096
  v_mfma_f32_16x16x32_bf16 v[208:211], v[128:131], v[220:223], v[208:211]
  ds_read_b128 v[240:243], v247 offset:5120
  v_mfma_f32_16x16x32_bf16 v[204:207], v[56:59], v[224:227], v[204:207]
  ds_read_b128 v[184:187], v7 offset:43008
  v_mfma_f32_16x16x32_bf16 v[212:215], v[128:131], v[224:227], v[212:215]
  v_mfma_f32_16x16x32_bf16 v[216:219], v[160:163], v[224:227], v[216:219]
  s_waitcnt lgkmcnt(3)
  v_mfma_f32_16x16x32_bf16 v[200:203], v[60:63], v[228:231], v[200:203]
  ds_read_b128 v[220:223], v247 offset:6144
  v_mfma_f32_16x16x32_bf16 v[208:211], v[132:135], v[228:231], v[208:211]
  ds_read_b128 v[224:227], v247 offset:7168
  v_mfma_f32_16x16x32_bf16 v[204:207], v[60:63], v[232:235], v[204:207]
  ds_read_b128 v[196:199], v7 offset:44032
  v_mfma_f32_16x16x32_bf16 v[212:215], v[132:135], v[232:235], v[212:215]
  v_mfma_f32_16x16x32_bf16 v[216:219], v[172:175], v[232:235], v[216:219]
  s_waitcnt lgkmcnt(3)
  v_mfma_f32_16x16x32_bf16 v[200:203], v[64:67], v[236:239], v[200:203]
  ds_read_b128 v[228:231], v4 offset:32768
  v_mfma_f32_16x16x32_bf16 v[208:211], v[136:139], v[236:239], v[208:211]
  ds_read_b128 v[232:235], v4 offset:33792
  v_mfma_f32_16x16x32_bf16 v[204:207], v[64:67], v[240:243], v[204:207]
  ds_read_b128 v[160:163], v4 offset:57344
  v_mfma_f32_16x16x32_bf16 v[212:215], v[136:139], v[240:243], v[212:215]
  v_mfma_f32_16x16x32_bf16 v[216:219], v[184:187], v[240:243], v[216:219]
  s_waitcnt lgkmcnt(3)
  v_mfma_f32_16x16x32_bf16 v[200:203], v[68:71], v[220:223], v[200:203]
  ds_read_b128 v[236:239], v4 offset:34816
  v_mfma_f32_16x16x32_bf16 v[208:211], v[140:143], v[220:223], v[208:211]
  ds_read_b128 v[240:243], v4 offset:35840
  v_mfma_f32_16x16x32_bf16 v[204:207], v[68:71], v[224:227], v[204:207]
  ds_read_b128 v[172:175], v4 offset:58368
  v_mfma_f32_16x16x32_bf16 v[212:215], v[140:143], v[224:227], v[212:215]
  v_mfma_f32_16x16x32_bf16 v[216:219], v[196:199], v[224:227], v[216:219]
  s_waitcnt lgkmcnt(3)
  v_mfma_f32_16x16x32_bf16 v[200:203], v[72:75], v[228:231], v[200:203]
  v_mfma_f32_16x16x32_bf16 v[208:211], v[144:147], v[228:231], v[208:211]
  v_mfma_f32_16x16x32_bf16 v[204:207], v[72:75], v[232:235], v[204:207]
  v_mfma_f32_16x16x32_bf16 v[212:215], v[144:147], v[232:235], v[212:215]
  v_mfma_f32_16x16x32_bf16 v[216:219], v[160:163], v[232:235], v[216:219]
  s_waitcnt lgkmcnt(0)
  v_mfma_f32_16x16x32_bf16 v[200:203], v[76:79], v[236:239], v[200:203]
  v_mfma_f32_16x16x32_bf16 v[208:211], v[148:151], v[236:239], v[208:211]
  v_mfma_f32_16x16x32_bf16 v[204:207], v[76:79], v[240:243], v[204:207]
  v_mfma_f32_16x16x32_bf16 v[212:215], v[148:151], v[240:243], v[212:215]
  v_mfma_f32_16x16x32_bf16 v[216:219], v[172:175], v[240:243], v[216:219]
  s_nop 3
  v_cvt_pk_bf16_f32 v220, v200, v201
  v_cvt_pk_bf16_f32 v221, v202, v203
  v_cvt_pk_bf16_f32 v222, v208, v209
  v_cvt_pk_bf16_f32 v223, v210, v211
  ds_write_b128 v249, v[220:223] offset:0
  v_cvt_pk_bf16_f32 v224, v204, v205
  v_cvt_pk_bf16_f32 v225, v206, v207
  v_cvt_pk_bf16_f32 v226, v212, v213
  v_cvt_pk_bf16_f32 v227, v214, v215
  ds_write_b128 v249, v[224:227] offset:1024
  ds_read_b128 v[228:231], v250 offset:0
  ds_read_b128 v[232:235], v250 offset:1024
  s_waitcnt lgkmcnt(1)
  buffer_store_dwordx4 v[228:231], v251, s[56:59], s84 offen
  s_waitcnt lgkmcnt(0)
  buffer_store_dwordx4 v[232:235], v251, s[56:59], s85 offen
Lw23_28:
  v_cvt_pk_bf16_f32 v220, v216, v217
  v_cvt_pk_bf16_f32 v221, v218, v219
  buffer_store_dwordx2 v[220:221], v252, s[56:59], s86 offen offset:256
Lfin_25:
  s_endpgm
L_codeend:
.section .rodata,"a"
.p2align 6
.amdhsa_kernel concat_heads__ssm_conv_s4d__linear_kernel_hedgehog__prompt_kernel
  .amdhsa_next_free_vgpr 256
  .amdhsa_next_free_sgpr 102
  .amdhsa_accum_offset 256
  .amdhsa_group_segment_fixed_size 0
  .amdhsa_kernarg_size 112
  .amdhsa_user_sgpr_count 2
  .amdhsa_user_sgpr_kernarg_segment_ptr 1
  .amdhsa_system_sgpr_workgroup_id_x 1
.end_amdhsa_kernel
```
